```python
import torch

def _softmax(x, axis=-1):
    return torch.softmax(x, dim=axis)
def _gelu(x):
    return torch.nn.functional.gelu(x, approximate="tanh")
def _silu(x):
    return torch.nn.functional.silu(x)
def _sigmoid(x):
    return torch.sigmoid(x)
def _layernorm(x, axis=-1, eps=1e-5):
    m = x.mean(dim=axis, keepdim=True)
    v = x.var(dim=axis, keepdim=True, unbiased=False)
    return (x - m) / torch.sqrt(v + eps)
def _scatter_add(tgt, idx, src, axis=0):
    return tgt.clone().index_add_(axis, idx, src)
def _segment_sum(src, seg, n):
    out = torch.zeros((n,) + src.shape[1:], dtype=src.dtype)
    return out.index_add_(0, seg, src)
def _pad(x, pw):
    flat = tuple(v for pair in reversed(pw) for v in pair)
    return torch.nn.functional.pad(x, flat)

kernel_name = 'recurrent_scan__grouped_kv_mqa__glu_gated_swiglu__prompt'

def setup_inputs():

    _w = (lambda a: (lambda t: t.to(torch.bfloat16) if t.is_floating_point() else t)(torch.as_tensor(a)))
    def _A_setup():
        B, S, D, H = 1, 2048, 512, 32
        Dh = D // H
        return {
            "x": _w((lambda *s: torch.randn(*s, dtype=torch.bfloat16) * 0.05)(B, S, D)),
            "wq": _w((lambda *s: torch.randn(*s, dtype=torch.bfloat16) * 0.2)(D, H * Dh)),
            "wk": _w((lambda *s: torch.randn(*s, dtype=torch.bfloat16) * 0.2)(D, Dh)),
            "wv": _w((lambda *s: torch.randn(*s, dtype=torch.bfloat16) * 0.2)(D, Dh)),
            "wo": _w((lambda *s: torch.randn(*s, dtype=torch.bfloat16) * 0.2)(H * Dh, D)),
        }
    _A_in = _A_setup()

    def _B_setup():
        B, S, D, F = 1, 2048, 512, 1376
        return {
            "x": _w((lambda *s: torch.randn(*s, dtype=torch.bfloat16) * 0.05)(B, S, D)),
            "w1": _w((lambda *s: torch.randn(*s, dtype=torch.bfloat16) * 0.1)(D, F) * (2.0 / D) ** 0.5),
            "w3": _w((lambda *s: torch.randn(*s, dtype=torch.bfloat16) * 0.1)(D, F) * (2.0 / D) ** 0.5),
            "w2": _w((lambda *s: torch.randn(*s, dtype=torch.bfloat16) * 0.1)(F, D) * (2.0 / F) ** 0.5),
        }
    _B_in = _B_setup()

    return {
        "A_x": _A_in["x"],
        "A_wq": _A_in["wq"],
        "A_wk": _A_in["wk"],
        "A_wv": _A_in["wv"],
        "A_wo": _A_in["wo"],
        "B_x": _B_in["x"],
        "B_w1": _B_in["w1"],
        "B_w3": _B_in["w3"],
        "B_w2": _B_in["w2"],
    }

def reference(A_x, A_wq, A_wk, A_wv, A_wo, B_x, B_w1, B_w3, B_w2):
    def _A_ref(x, wq, wk, wv, wo):
        B, S, D = x.shape
        H = 32
        Dh = D // H
        q = (lambda x, *d: x.permute(*d))((x @ wq).reshape(B, S, H, Dh), 0, 2, 1, 3)
        k = x @ wk
        v = x @ wv
        scores = torch.einsum("bhqd,bkd->bhqk", q, k) * (Dh ** -0.5)
        p = _softmax(scores, axis=-1)
        o = torch.einsum("bhqk,bkd->bhqd", p, v)
        return (lambda x, *d: x.permute(*d))(o, 0, 2, 1, 3).reshape(B, S, H * Dh) @ wo

    def _B_ref(x, w1, w3, w2):
        gate = torch.einsum("bsd,df->bsf", x, w1)
        up = torch.einsum("bsd,df->bsf", x, w3)
        h = _silu(gate) * up
        out = torch.einsum("bsf,fd->bsd", h, w2)
        return out

    x = A_x
    xn = _layernorm(x, axis=-1)
    s = _A_ref(xn, A_wq, A_wk, A_wv, A_wo)
    g = _silu(_B_ref(xn, B_w1, B_w3, B_w2))
    return x + s * g
```

```asm
; @launch grid=(256,1,1) block=(768,1,1) lds=163840
.amdgcn_target "amdgcn-amd-amdhsa--gfx950"
.text
.globl recurrent_scan__grouped_kv_mqa__glu_gated_swiglu__prompt_kernel
.p2align 8
.type recurrent_scan__grouped_kv_mqa__glu_gated_swiglu__prompt_kernel,@function
recurrent_scan__grouped_kv_mqa__glu_gated_swiglu__prompt_kernel:
    s_load_dwordx16 s[16:31], s[0:1], 0
    s_load_dwordx8 s[32:39], s[0:1], 64
    s_cmp_ge_u32 s2, 256
    s_cbranch_scc1 k_exit
    v_lshrrev_b32 v1, 6, v0
    s_and_b32 s4, s2, 7
    s_lshr_b32 s5, s2, 3
    v_readfirstlane_b32 s8, v1
    s_and_b32 s5, s5, 3
    s_lshr_b32 s6, s2, 5
    s_lshl_b32 s7, s4, 2
    s_add_u32 s7, s7, s5
    s_sub_u32 s3, 7, s6
    v_and_b32 v0, 63, v0
    v_lshlrev_b32 v1, 4, v0
    s_mul_i32 s66, s8, 5
    s_mul_i32 s67, s8, 6
    s_sub_u32 s67, s67, 8
    s_cmp_ge_u32 s8, 8
    s_cselect_b32 s66, s67, s66
    s_mul_i32 s67, s66, 1040
    s_add_u32 s67, s67, 65536
    s_lshl_b32 s68, s7, 6
    s_add_u32 s66, s66, s68
    s_lshl_b32 s66, s66, 10
    s_mov_b32 s50, 2097152
    s_mov_b32 s51, 0x20000
    s_waitcnt lgkmcnt(0)
    s_mov_b32 s48, s16
    s_mov_b32 s49, s17
    s_mov_b32 m0, s67
    s_add_u32 s67, s67, 1040
    buffer_load_dwordx4 v1, s[48:51], s66 offen lds
    s_add_u32 s66, s66, 1024
    s_mov_b32 m0, s67
    s_add_u32 s67, s67, 1040
    buffer_load_dwordx4 v1, s[48:51], s66 offen lds
    s_add_u32 s66, s66, 1024
    s_mov_b32 m0, s67
    s_add_u32 s67, s67, 1040
    buffer_load_dwordx4 v1, s[48:51], s66 offen lds
    s_add_u32 s66, s66, 1024
    s_mov_b32 m0, s67
    s_add_u32 s67, s67, 1040
    buffer_load_dwordx4 v1, s[48:51], s66 offen lds
    s_add_u32 s66, s66, 1024
    s_mov_b32 m0, s67
    s_add_u32 s67, s67, 1040
    buffer_load_dwordx4 v1, s[48:51], s66 offen lds
    s_add_u32 s66, s66, 1024
    s_load_dword s15, s[38:39], 0x30000
    v_and_b32 v2, 31, v0
    v_lshrrev_b32 v3, 5, v0
    v_lshrrev_b32 v4, 3, v0
    v_bfe_u32 v10, v4, 1, 1
    v_lshlrev_b32 v10, 2, v10
    v_and_b32 v11, 7, v0
    v_xor_b32 v10, v10, v11
    v_lshlrev_b32 v10, 4, v10
    v_lshl_add_u32 v4, v4, 10, v10
    s_mov_b32 s52, s18
    s_mov_b32 s53, s19
    s_mov_b32 s54, 524288
    s_mov_b32 s55, 0x20000
    s_cmp_ge_u32 s8, 8
    s_cbranch_scc1 k_g
    s_lshl_b32 s66, s8, 15
    s_lshl_b32 s68, s6, 7
    s_add_u32 s66, s66, s68
    s_lshl_b32 s67, s8, 12
    s_mov_b32 m0, s67
    s_add_u32 s67, s67, 1024
    buffer_load_dwordx4 v4, s[52:55], s66 offen lds
    s_add_u32 s66, s66, 8192
    s_mov_b32 m0, s67
    s_add_u32 s67, s67, 1024
    buffer_load_dwordx4 v4, s[52:55], s66 offen lds
    s_add_u32 s66, s66, 8192
    s_mov_b32 m0, s67
    s_add_u32 s67, s67, 1024
    buffer_load_dwordx4 v4, s[52:55], s66 offen lds
    s_add_u32 s66, s66, 8192
    s_mov_b32 m0, s67
    s_add_u32 s67, s67, 1024
    buffer_load_dwordx4 v4, s[52:55], s66 offen lds
    s_add_u32 s66, s66, 8192
    s_mov_b32 s40, s38
    s_mov_b32 s41, s39
    s_mov_b32 s42, 10485760
    s_mov_b32 s43, 0x20000
    s_add_u32 s44, s38, 0
    s_addc_u32 s45, s39, 0
    s_mov_b32 s46, 0x20000
    s_mov_b32 s47, 0x20000
    s_mov_b32 s60, s36
    s_mov_b32 s61, s37
    s_mov_b32 s62, 256
    s_mov_b32 s63, 0x20000
    s_and_b32 s9, s8, 1
    s_lshr_b32 s10, s8, 1
    v_mul_u32_u24 v7, 1040, v2
    v_lshl_add_u32 v7, v3, 4, v7
    s_mul_i32 s66, s9, 33280
    s_lshl_b32 s67, s10, 8
    s_add_u32 s67, s67, s66
    s_add_u32 s67, s67, 65536
    v_add_u32 v8, s67, v7
    s_waitcnt vmcnt(4) lgkmcnt(0)
    s_add_u32 s15, s15, 1
    s_barrier
    ds_read_b128 v[16:19], v8 offset:0
    ds_read_b128 v[20:23], v8 offset:32
    ds_read_b128 v[24:27], v8 offset:64
    ds_read_b128 v[28:31], v8 offset:96
    ds_read_b128 v[32:35], v8 offset:128
    ds_read_b128 v[36:39], v8 offset:160
    ds_read_b128 v[40:43], v8 offset:192
    ds_read_b128 v[44:47], v8 offset:224
    v_mov_b32 v9, 0x3f803f80
    v_mov_b32 v10, 0
    v_mov_b32 v11, 0
    v_mov_b32 v12, 0
    v_mov_b32 v13, 0
    s_waitcnt lgkmcnt(7)
    v_dot2_f32_bf16 v10, v16, v9, v10
    v_dot2_f32_bf16 v12, v16, v16, v12
    v_dot2_f32_bf16 v11, v17, v9, v11
    v_dot2_f32_bf16 v13, v17, v17, v13
    v_dot2_f32_bf16 v10, v18, v9, v10
    v_dot2_f32_bf16 v12, v18, v18, v12
    v_dot2_f32_bf16 v11, v19, v9, v11
    v_dot2_f32_bf16 v13, v19, v19, v13
    s_waitcnt lgkmcnt(6)
    v_dot2_f32_bf16 v10, v20, v9, v10
    v_dot2_f32_bf16 v12, v20, v20, v12
    v_dot2_f32_bf16 v11, v21, v9, v11
    v_dot2_f32_bf16 v13, v21, v21, v13
    v_dot2_f32_bf16 v10, v22, v9, v10
    v_dot2_f32_bf16 v12, v22, v22, v12
    v_dot2_f32_bf16 v11, v23, v9, v11
    v_dot2_f32_bf16 v13, v23, v23, v13
    s_waitcnt lgkmcnt(5)
    v_dot2_f32_bf16 v10, v24, v9, v10
    v_dot2_f32_bf16 v12, v24, v24, v12
    v_dot2_f32_bf16 v11, v25, v9, v11
    v_dot2_f32_bf16 v13, v25, v25, v13
    v_dot2_f32_bf16 v10, v26, v9, v10
    v_dot2_f32_bf16 v12, v26, v26, v12
    v_dot2_f32_bf16 v11, v27, v9, v11
    v_dot2_f32_bf16 v13, v27, v27, v13
    s_waitcnt lgkmcnt(4)
    v_dot2_f32_bf16 v10, v28, v9, v10
    v_dot2_f32_bf16 v12, v28, v28, v12
    v_dot2_f32_bf16 v11, v29, v9, v11
    v_dot2_f32_bf16 v13, v29, v29, v13
    v_dot2_f32_bf16 v10, v30, v9, v10
    v_dot2_f32_bf16 v12, v30, v30, v12
    v_dot2_f32_bf16 v11, v31, v9, v11
    v_dot2_f32_bf16 v13, v31, v31, v13
    s_waitcnt lgkmcnt(3)
    v_dot2_f32_bf16 v10, v32, v9, v10
    v_dot2_f32_bf16 v12, v32, v32, v12
    v_dot2_f32_bf16 v11, v33, v9, v11
    v_dot2_f32_bf16 v13, v33, v33, v13
    v_dot2_f32_bf16 v10, v34, v9, v10
    v_dot2_f32_bf16 v12, v34, v34, v12
    v_dot2_f32_bf16 v11, v35, v9, v11
    v_dot2_f32_bf16 v13, v35, v35, v13
    s_waitcnt lgkmcnt(2)
    v_dot2_f32_bf16 v10, v36, v9, v10
    v_dot2_f32_bf16 v12, v36, v36, v12
    v_dot2_f32_bf16 v11, v37, v9, v11
    v_dot2_f32_bf16 v13, v37, v37, v13
    v_dot2_f32_bf16 v10, v38, v9, v10
    v_dot2_f32_bf16 v12, v38, v38, v12
    v_dot2_f32_bf16 v11, v39, v9, v11
    v_dot2_f32_bf16 v13, v39, v39, v13
    s_waitcnt lgkmcnt(1)
    v_dot2_f32_bf16 v10, v40, v9, v10
    v_dot2_f32_bf16 v12, v40, v40, v12
    v_dot2_f32_bf16 v11, v41, v9, v11
    v_dot2_f32_bf16 v13, v41, v41, v13
    v_dot2_f32_bf16 v10, v42, v9, v10
    v_dot2_f32_bf16 v12, v42, v42, v12
    v_dot2_f32_bf16 v11, v43, v9, v11
    v_dot2_f32_bf16 v13, v43, v43, v13
    s_waitcnt lgkmcnt(0)
    v_dot2_f32_bf16 v10, v44, v9, v10
    v_dot2_f32_bf16 v12, v44, v44, v12
    v_dot2_f32_bf16 v11, v45, v9, v11
    v_dot2_f32_bf16 v13, v45, v45, v13
    v_dot2_f32_bf16 v10, v46, v9, v10
    v_dot2_f32_bf16 v12, v46, v46, v12
    v_dot2_f32_bf16 v11, v47, v9, v11
    v_dot2_f32_bf16 v13, v47, v47, v13
    s_nop 1
    v_add_f32 v10, v10, v11
    v_add_f32 v12, v12, v13
    v_mov_b32 v11, v10
    v_mov_b32 v13, v12
    s_nop 0
    v_permlane32_swap_b32 v10, v11
    v_permlane32_swap_b32 v12, v13
    s_lshl_b32 s66, s9, 10
    s_lshl_b32 s67, s10, 8
    s_add_u32 s66, s66, s67
    s_add_u32 s66, s66, 159744
    v_lshlrev_b32 v14, 3, v2
    v_add_u32 v14, s66, v14
    v_add_f32 v10, v10, v11
    v_add_f32 v11, v12, v13
    ds_write_b64 v14, v[10:11]
    s_lshr_b32 s11, s8, 2
    s_bfe_u32 s12, s8, 0x10001
    v_bfe_u32 v5, v0, 2, 2
    v_lshl_add_u32 v5, v3, 3, v5
    v_lshlrev_b32 v5, 7, v5
    v_bfe_u32 v14, v0, 4, 1
    v_lshlrev_b32 v14, 1, v14
    v_bfe_u32 v15, v0, 1, 1
    v_add_u32 v14, v14, v15
    v_bfe_u32 v15, v0, 3, 1
    v_lshlrev_b32 v15, 2, v15
    v_xor_b32 v14, v14, v15
    v_lshl_add_u32 v5, v14, 4, v5
    v_and_b32 v14, 1, v0
    v_lshl_add_u32 v5, v14, 3, v5
    s_lshl_b32 s66, s11, 6
    v_xor_b32 v5, s66, v5
    s_lshl_b32 s66, s12, 15
    s_add_u32 s66, s66, 0
    v_add_u32 v5, s66, v5
    s_mul_i32 s66, s9, 33280
    s_lshl_b32 s67, s12, 9
    s_add_u32 s66, s66, s67
    s_add_u32 s66, s66, 65536
    v_add_u32 v6, s66, v7
    s_waitcnt vmcnt(0) lgkmcnt(0)
    s_barrier
    v_mov_b32 v108, 163776
    s_lshl_b32 s66, s9, 10
    s_add_u32 s66, s66, 159744
    v_lshlrev_b32 v13, 3, v2
    v_add_u32 v13, s66, v13
    ds_read_b64 v[80:81], v13 offset:0
    ds_read_b64 v[82:83], v13 offset:256
    ds_read_b64 v[84:85], v13 offset:512
    ds_read_b64 v[86:87], v13 offset:768
    s_waitcnt lgkmcnt(0)
    v_add_f32 v80, v80, v82
    v_add_f32 v81, v81, v83
    v_add_f32 v84, v84, v86
    v_add_f32 v85, v85, v87
    v_add_f32 v80, v80, v84
    v_add_f32 v81, v81, v85
    v_mul_f32 v80, 0x3b000000, v80
    v_mul_f32 v81, 0x3b000000, v81
    v_fma_f32 v81, -v80, v80, v81
    v_max_f32 v81, 0, v81
    v_add_f32 v81, 0x3727c5ac, v81
    v_rsq_f32 v81, v81
    s_nop 0
    v_mul_f32 v83, v80, v81
    v_sub_f32 v83, 0, v83
    s_cmp_ge_u32 s3, 2
    s_cbranch_scc1 a_nokvw
a_kvw:
    ds_read_b32 v109, v108 offset:36
    s_waitcnt lgkmcnt(0)
    v_readfirstlane_b32 s66, v109
    s_nop 0
    s_cmp_ge_u32 s66, 4
    s_cbranch_scc0 a_kvw
a_nokvw:
    v_mov_b32 v15, 0xffff0000
    v_lshlrev_b32 v50, 16, v16
    v_and_b32 v51, v15, v16
    v_fma_f32 v50, v50, v81, v83
    v_fma_f32 v51, v51, v81, v83
    v_cvt_pk_bf16_f32 v16, v50, v51
    v_lshlrev_b32 v52, 16, v17
    v_and_b32 v53, v15, v17
    v_fma_f32 v52, v52, v81, v83
    v_fma_f32 v53, v53, v81, v83
    v_cvt_pk_bf16_f32 v17, v52, v53
    v_lshlrev_b32 v50, 16, v18
    v_and_b32 v51, v15, v18
    v_fma_f32 v50, v50, v81, v83
    v_fma_f32 v51, v51, v81, v83
    v_cvt_pk_bf16_f32 v18, v50, v51
    v_lshlrev_b32 v52, 16, v19
    v_and_b32 v53, v15, v19
    v_fma_f32 v52, v52, v81, v83
    v_fma_f32 v53, v53, v81, v83
    v_cvt_pk_bf16_f32 v19, v52, v53
    ds_write_b128 v8, v[16:19] offset:0
    v_lshlrev_b32 v50, 16, v20
    v_and_b32 v51, v15, v20
    v_fma_f32 v50, v50, v81, v83
    v_fma_f32 v51, v51, v81, v83
    v_cvt_pk_bf16_f32 v20, v50, v51
    v_lshlrev_b32 v52, 16, v21
    v_and_b32 v53, v15, v21
    v_fma_f32 v52, v52, v81, v83
    v_fma_f32 v53, v53, v81, v83
    v_cvt_pk_bf16_f32 v21, v52, v53
    v_lshlrev_b32 v50, 16, v22
    v_and_b32 v51, v15, v22
    v_fma_f32 v50, v50, v81, v83
    v_fma_f32 v51, v51, v81, v83
    v_cvt_pk_bf16_f32 v22, v50, v51
    v_lshlrev_b32 v52, 16, v23
    v_and_b32 v53, v15, v23
    v_fma_f32 v52, v52, v81, v83
    v_fma_f32 v53, v53, v81, v83
    v_cvt_pk_bf16_f32 v23, v52, v53
    ds_write_b128 v8, v[20:23] offset:32
    v_lshlrev_b32 v50, 16, v24
    v_and_b32 v51, v15, v24
    v_fma_f32 v50, v50, v81, v83
    v_fma_f32 v51, v51, v81, v83
    v_cvt_pk_bf16_f32 v24, v50, v51
    v_lshlrev_b32 v52, 16, v25
    v_and_b32 v53, v15, v25
    v_fma_f32 v52, v52, v81, v83
    v_fma_f32 v53, v53, v81, v83
    v_cvt_pk_bf16_f32 v25, v52, v53
    v_lshlrev_b32 v50, 16, v26
    v_and_b32 v51, v15, v26
    v_fma_f32 v50, v50, v81, v83
    v_fma_f32 v51, v51, v81, v83
    v_cvt_pk_bf16_f32 v26, v50, v51
    v_lshlrev_b32 v52, 16, v27
    v_and_b32 v53, v15, v27
    v_fma_f32 v52, v52, v81, v83
    v_fma_f32 v53, v53, v81, v83
    v_cvt_pk_bf16_f32 v27, v52, v53
    ds_write_b128 v8, v[24:27] offset:64
    v_lshlrev_b32 v50, 16, v28
    v_and_b32 v51, v15, v28
    v_fma_f32 v50, v50, v81, v83
    v_fma_f32 v51, v51, v81, v83
    v_cvt_pk_bf16_f32 v28, v50, v51
    v_lshlrev_b32 v52, 16, v29
    v_and_b32 v53, v15, v29
    v_fma_f32 v52, v52, v81, v83
    v_fma_f32 v53, v53, v81, v83
    v_cvt_pk_bf16_f32 v29, v52, v53
    v_lshlrev_b32 v50, 16, v30
    v_and_b32 v51, v15, v30
    v_fma_f32 v50, v50, v81, v83
    v_fma_f32 v51, v51, v81, v83
    v_cvt_pk_bf16_f32 v30, v50, v51
    v_lshlrev_b32 v52, 16, v31
    v_and_b32 v53, v15, v31
    v_fma_f32 v52, v52, v81, v83
    v_fma_f32 v53, v53, v81, v83
    v_cvt_pk_bf16_f32 v31, v52, v53
    ds_write_b128 v8, v[28:31] offset:96
    v_lshlrev_b32 v50, 16, v32
    v_and_b32 v51, v15, v32
    v_fma_f32 v50, v50, v81, v83
    v_fma_f32 v51, v51, v81, v83
    v_cvt_pk_bf16_f32 v32, v50, v51
    v_lshlrev_b32 v52, 16, v33
    v_and_b32 v53, v15, v33
    v_fma_f32 v52, v52, v81, v83
    v_fma_f32 v53, v53, v81, v83
    v_cvt_pk_bf16_f32 v33, v52, v53
    v_lshlrev_b32 v50, 16, v34
    v_and_b32 v51, v15, v34
    v_fma_f32 v50, v50, v81, v83
    v_fma_f32 v51, v51, v81, v83
    v_cvt_pk_bf16_f32 v34, v50, v51
    v_lshlrev_b32 v52, 16, v35
    v_and_b32 v53, v15, v35
    v_fma_f32 v52, v52, v81, v83
    v_fma_f32 v53, v53, v81, v83
    v_cvt_pk_bf16_f32 v35, v52, v53
    ds_write_b128 v8, v[32:35] offset:128
    v_lshlrev_b32 v50, 16, v36
    v_and_b32 v51, v15, v36
    v_fma_f32 v50, v50, v81, v83
    v_fma_f32 v51, v51, v81, v83
    v_cvt_pk_bf16_f32 v36, v50, v51
    v_lshlrev_b32 v52, 16, v37
    v_and_b32 v53, v15, v37
    v_fma_f32 v52, v52, v81, v83
    v_fma_f32 v53, v53, v81, v83
    v_cvt_pk_bf16_f32 v37, v52, v53
    v_lshlrev_b32 v50, 16, v38
    v_and_b32 v51, v15, v38
    v_fma_f32 v50, v50, v81, v83
    v_fma_f32 v51, v51, v81, v83
    v_cvt_pk_bf16_f32 v38, v50, v51
    v_lshlrev_b32 v52, 16, v39
    v_and_b32 v53, v15, v39
    v_fma_f32 v52, v52, v81, v83
    v_fma_f32 v53, v53, v81, v83
    v_cvt_pk_bf16_f32 v39, v52, v53
    ds_write_b128 v8, v[36:39] offset:160
    v_lshlrev_b32 v50, 16, v40
    v_and_b32 v51, v15, v40
    v_fma_f32 v50, v50, v81, v83
    v_fma_f32 v51, v51, v81, v83
    v_cvt_pk_bf16_f32 v40, v50, v51
    v_lshlrev_b32 v52, 16, v41
    v_and_b32 v53, v15, v41
    v_fma_f32 v52, v52, v81, v83
    v_fma_f32 v53, v53, v81, v83
    v_cvt_pk_bf16_f32 v41, v52, v53
    v_lshlrev_b32 v50, 16, v42
    v_and_b32 v51, v15, v42
    v_fma_f32 v50, v50, v81, v83
    v_fma_f32 v51, v51, v81, v83
    v_cvt_pk_bf16_f32 v42, v50, v51
    v_lshlrev_b32 v52, 16, v43
    v_and_b32 v53, v15, v43
    v_fma_f32 v52, v52, v81, v83
    v_fma_f32 v53, v53, v81, v83
    v_cvt_pk_bf16_f32 v43, v52, v53
    ds_write_b128 v8, v[40:43] offset:192
    v_lshlrev_b32 v50, 16, v44
    v_and_b32 v51, v15, v44
    v_fma_f32 v50, v50, v81, v83
    v_fma_f32 v51, v51, v81, v83
    v_cvt_pk_bf16_f32 v44, v50, v51
    v_lshlrev_b32 v52, 16, v45
    v_and_b32 v53, v15, v45
    v_fma_f32 v52, v52, v81, v83
    v_fma_f32 v53, v53, v81, v83
    v_cvt_pk_bf16_f32 v45, v52, v53
    v_lshlrev_b32 v50, 16, v46
    v_and_b32 v51, v15, v46
    v_fma_f32 v50, v50, v81, v83
    v_fma_f32 v51, v51, v81, v83
    v_cvt_pk_bf16_f32 v46, v50, v51
    v_lshlrev_b32 v52, 16, v47
    v_and_b32 v53, v15, v47
    v_fma_f32 v52, v52, v81, v83
    v_fma_f32 v53, v53, v81, v83
    v_cvt_pk_bf16_f32 v47, v52, v53
    ds_write_b128 v8, v[44:47] offset:224
    s_waitcnt lgkmcnt(0)
    v_mov_b32 v109, 1
    s_mov_b64 exec, 1
    ds_add_u32 v108, v109 offset:40
    s_mov_b64 exec, -1
a_xnw:
    ds_read_b32 v109, v108 offset:40
    s_waitcnt lgkmcnt(0)
    v_readfirstlane_b32 s66, v109
    s_nop 0
    s_cmp_ge_u32 s66, 8
    s_cbranch_scc0 a_xnw
    ds_read_b64_tr_b16 v[80:81], v5 offset:0
    ds_read_b64_tr_b16 v[82:83], v5 offset:512
    ds_read_b128 v[92:95], v6 offset:0
    ds_read_b64_tr_b16 v[84:85], v5 offset:2048
    ds_read_b64_tr_b16 v[86:87], v5 offset:2560
    ds_read_b128 v[96:99], v6 offset:32
    ds_read_b64_tr_b16 v[88:89], v5 offset:4096
    ds_read_b64_tr_b16 v[90:91], v5 offset:4608
    ds_read_b128 v[100:103], v6 offset:64
    s_waitcnt lgkmcnt(6)
    v_mfma_f32_32x32x16_bf16 v[64:79], v[80:83], v[92:95], 0
    ds_read_b64_tr_b16 v[80:81], v5 offset:6144
    ds_read_b64_tr_b16 v[82:83], v5 offset:6656
    ds_read_b128 v[92:95], v6 offset:96
    s_waitcnt lgkmcnt(6)
    v_mfma_f32_32x32x16_bf16 v[64:79], v[84:87], v[96:99], v[64:79]
    ds_read_b64_tr_b16 v[84:85], v5 offset:8192
    ds_read_b64_tr_b16 v[86:87], v5 offset:8704
    ds_read_b128 v[96:99], v6 offset:128
    s_waitcnt lgkmcnt(6)
    v_mfma_f32_32x32x16_bf16 v[64:79], v[88:91], v[100:103], v[64:79]
    ds_read_b64_tr_b16 v[88:89], v5 offset:10240
    ds_read_b64_tr_b16 v[90:91], v5 offset:10752
    ds_read_b128 v[100:103], v6 offset:160
    s_waitcnt lgkmcnt(6)
    v_mfma_f32_32x32x16_bf16 v[64:79], v[80:83], v[92:95], v[64:79]
    ds_read_b64_tr_b16 v[80:81], v5 offset:12288
    ds_read_b64_tr_b16 v[82:83], v5 offset:12800
    ds_read_b128 v[92:95], v6 offset:192
    s_waitcnt lgkmcnt(6)
    v_mfma_f32_32x32x16_bf16 v[64:79], v[84:87], v[96:99], v[64:79]
    ds_read_b64_tr_b16 v[84:85], v5 offset:14336
    ds_read_b64_tr_b16 v[86:87], v5 offset:14848
    ds_read_b128 v[96:99], v6 offset:224
    s_waitcnt lgkmcnt(6)
    v_mfma_f32_32x32x16_bf16 v[64:79], v[88:91], v[100:103], v[64:79]
    ds_read_b64_tr_b16 v[88:89], v5 offset:16384
    ds_read_b64_tr_b16 v[90:91], v5 offset:16896
    ds_read_b128 v[100:103], v6 offset:256
    s_waitcnt lgkmcnt(6)
    v_mfma_f32_32x32x16_bf16 v[64:79], v[80:83], v[92:95], v[64:79]
    ds_read_b64_tr_b16 v[80:81], v5 offset:18432
    ds_read_b64_tr_b16 v[82:83], v5 offset:18944
    ds_read_b128 v[92:95], v6 offset:288
    s_waitcnt lgkmcnt(6)
    v_mfma_f32_32x32x16_bf16 v[64:79], v[84:87], v[96:99], v[64:79]
    ds_read_b64_tr_b16 v[84:85], v5 offset:20480
    ds_read_b64_tr_b16 v[86:87], v5 offset:20992
    ds_read_b128 v[96:99], v6 offset:320
    s_waitcnt lgkmcnt(6)
    v_mfma_f32_32x32x16_bf16 v[64:79], v[88:91], v[100:103], v[64:79]
    ds_read_b64_tr_b16 v[88:89], v5 offset:22528
    ds_read_b64_tr_b16 v[90:91], v5 offset:23040
    ds_read_b128 v[100:103], v6 offset:352
    s_waitcnt lgkmcnt(6)
    v_mfma_f32_32x32x16_bf16 v[64:79], v[80:83], v[92:95], v[64:79]
    ds_read_b64_tr_b16 v[80:81], v5 offset:24576
    ds_read_b64_tr_b16 v[82:83], v5 offset:25088
    ds_read_b128 v[92:95], v6 offset:384
    s_waitcnt lgkmcnt(6)
    v_mfma_f32_32x32x16_bf16 v[64:79], v[84:87], v[96:99], v[64:79]
    ds_read_b64_tr_b16 v[84:85], v5 offset:26624
    ds_read_b64_tr_b16 v[86:87], v5 offset:27136
    ds_read_b128 v[96:99], v6 offset:416
    s_waitcnt lgkmcnt(6)
    v_mfma_f32_32x32x16_bf16 v[64:79], v[88:91], v[100:103], v[64:79]
    ds_read_b64_tr_b16 v[88:89], v5 offset:28672
    ds_read_b64_tr_b16 v[90:91], v5 offset:29184
    ds_read_b128 v[100:103], v6 offset:448
    s_waitcnt lgkmcnt(6)
    v_mfma_f32_32x32x16_bf16 v[64:79], v[80:83], v[92:95], v[64:79]
    ds_read_b64_tr_b16 v[80:81], v5 offset:30720
    ds_read_b64_tr_b16 v[82:83], v5 offset:31232
    ds_read_b128 v[92:95], v6 offset:480
    s_waitcnt lgkmcnt(6)
    v_mfma_f32_32x32x16_bf16 v[64:79], v[84:87], v[96:99], v[64:79]
    s_waitcnt lgkmcnt(3)
    v_mfma_f32_32x32x16_bf16 v[64:79], v[88:91], v[100:103], v[64:79]
    s_waitcnt lgkmcnt(0)
    v_mfma_f32_32x32x16_bf16 v[64:79], v[80:83], v[92:95], v[64:79]
    s_waitcnt lgkmcnt(0)
    s_mov_b64 exec, 1
    v_mov_b32 v109, 1
    ds_add_u32 v108, v109 offset:32
    s_mov_b64 exec, -1
as_4:
    ds_read_b32 v109, v108 offset:32
    s_waitcnt lgkmcnt(0)
    v_readfirstlane_b32 s66, v109
    s_nop 0
    s_cmp_ge_u32 s66, 8
    s_cbranch_scc0 as_4
    s_lshl_b32 s66, s8, 11
    s_add_u32 s66, s66, 0
    v_add_u32 v14, s66, v1
    s_xor_b32 s67, s8, 2
    s_lshl_b32 s67, s67, 11
    s_add_u32 s67, s67, 0
    v_add_u32 v15, s67, v1
    s_cmp_eq_u32 s12, 0
    s_cbranch_scc0 a_kh1
    ds_write_b128 v14, v[72:75]
    ds_write_b128 v14, v[76:79] offset:1024
    v_mov_b32 v48, v64
    v_mov_b32 v49, v65
    v_mov_b32 v50, v66
    v_mov_b32 v51, v67
    v_mov_b32 v52, v68
    v_mov_b32 v53, v69
    v_mov_b32 v54, v70
    v_mov_b32 v55, v71
    s_branch a_khj
a_kh1:
    ds_write_b128 v14, v[64:67]
    ds_write_b128 v14, v[68:71] offset:1024
    v_mov_b32 v48, v72
    v_mov_b32 v49, v73
    v_mov_b32 v50, v74
    v_mov_b32 v51, v75
    v_mov_b32 v52, v76
    v_mov_b32 v53, v77
    v_mov_b32 v54, v78
    v_mov_b32 v55, v79
a_khj:
    s_waitcnt lgkmcnt(0)
    s_mov_b64 exec, 1
    v_mov_b32 v109, 1
    ds_add_u32 v108, v109 offset:32
    s_mov_b64 exec, -1
as_5:
    ds_read_b32 v109, v108 offset:32
    s_waitcnt lgkmcnt(0)
    v_readfirstlane_b32 s66, v109
    s_nop 0
    s_cmp_ge_u32 s66, 16
    s_cbranch_scc0 as_5
    ds_read_b128 v[56:59], v15
    ds_read_b128 v[60:63], v15 offset:1024
    s_mov_b32 s68, 0x3eb8aa3b
    s_waitcnt lgkmcnt(0)
    v_mov_b32 v109, 1
    s_mov_b64 exec, 1
    ds_add_u32 v108, v109 offset:32
    s_mov_b64 exec, -1
    v_add_f32 v48, v48, v56
    v_add_f32 v49, v49, v57
    v_add_f32 v50, v50, v58
    v_add_f32 v51, v51, v59
    v_add_f32 v52, v52, v60
    v_add_f32 v53, v53, v61
    v_add_f32 v54, v54, v62
    v_add_f32 v55, v55, v63
    v_mul_f32 v48, s68, v48
    v_mul_f32 v49, s68, v49
    v_mul_f32 v50, s68, v50
    v_mul_f32 v51, s68, v51
    v_mul_f32 v52, s68, v52
    v_mul_f32 v53, s68, v53
    v_mul_f32 v54, s68, v54
    v_mul_f32 v55, s68, v55
    v_cvt_pk_bf16_f32 v4, v48, v49
    v_cvt_pk_bf16_f32 v5, v50, v51
    v_cvt_pk_bf16_f32 v6, v52, v53
    v_cvt_pk_bf16_f32 v7, v54, v55
    s_waitcnt vmcnt(0)
    s_cmp_eq_u32 s8, 0
    s_cbranch_scc0 a_noep0
    v_lshlrev_b32 v113, 2, v0
    s_and_b32 s67, s2, 15
    s_lshl_b32 s67, s67, 8
    s_add_u32 s67, s67, 131072
    buffer_load_dword v112, v113, s[40:43], s67 offen sc1
a_noep0:
    v_add_u32 v8, 0, v1
    v_add_u32 v9, 8192, v1
    v_and_b32 v15, 15, v0
    v_lshlrev_b32 v15, 4, v15
    v_lshl_add_u32 v15, v3, 8, v15
    v_add_u32 v10, 1024, v15
    v_add_u32 v11, 9216, v15
    v_mov_b32 v12, 163776
    v_mov_b32 v13, 1
    s_mov_b32 s64, 0xffff
    s_mov_b32 s65, 0xffff
    v_and_b32 v15, 27, v0
    v_cmp_eq_u32 vcc, 16, v15
    v_mov_b32 v15, 0x3f803f80
    v_mov_b32 v56, 0
    v_mov_b32 v57, 0
    v_mov_b32 v58, 0
    v_mov_b32 v59, 0
    v_mov_b32 v60, 0
    v_mov_b32 v61, 0
    v_mov_b32 v62, 0
    v_mov_b32 v63, 0
    v_mov_b32 v64, 0
    v_mov_b32 v65, 0
    v_mov_b32 v66, 0
    v_mov_b32 v67, 0
    v_mov_b32 v68, 0
    v_mov_b32 v69, 0
    v_mov_b32 v70, 0
    v_mov_b32 v71, 0
    v_cndmask_b32 v15, 0, v15, vcc
    v_mov_b32 v48, 0
    v_mov_b32 v49, 0
    v_mov_b32 v50, 0
    v_mov_b32 v51, 0
    v_mov_b32 v52, 0
    v_mov_b32 v53, 0
    v_mov_b32 v54, 0
    v_mov_b32 v55, 0
    v_mov_b32 v96, v15
    v_mov_b32 v97, v15
    v_mov_b32 v98, v15
    v_mov_b32 v99, v15
    v_mov_b32 v100, v15
    v_mov_b32 v101, v15
    v_mov_b32 v102, v15
    v_mov_b32 v103, v15
    v_mov_b32 v104, v15
    v_mov_b32 v105, v15
    v_mov_b32 v106, v15
    v_mov_b32 v107, v15
    v_mov_b32 v108, v15
    v_mov_b32 v109, v15
    v_mov_b32 v110, v15
    v_mov_b32 v111, v15
    s_lshr_b32 s75, s7, 1
    s_cmp_eq_u32 s8, 0
    s_cbranch_scc0 a_wlds
    v_lshlrev_b32 v15, 2, v0
    s_and_b32 s67, s2, 15
    s_lshl_b32 s67, s67, 8
    s_add_u32 s67, s67, 131072
    s_lshl_b32 s68, s75, 2
    s_mov_b64 s[76:77], 0xfff
    s_lshl_b64 s[78:79], s[76:77], s68
    s_sub_u32 s69, 64, s68
    s_lshr_b64 s[76:77], s[76:77], s69
    s_cmp_eq_u32 s68, 0
    s_cselect_b64 s[76:77], 0, s[76:77]
    s_or_b64 s[76:77], s[76:77], s[78:79]
    s_waitcnt vmcnt(0)
    v_mov_b32 v16, v112
    s_branch pf_kv_chk
pf_kv:
    buffer_load_dword v16, v15, s[40:43], s67 offen sc1
    s_waitcnt vmcnt(0)
pf_kv_chk:
    v_cmp_ne_u32 vcc, s15, v16
    s_nop 0
    s_and_b64 s[78:79], vcc, s[76:77]
    s_cmp_eq_u64 s[78:79], 0
    s_cbranch_scc1 pf_kv_ok
    s_sleep 2
    s_branch pf_kv
pf_kv_ok:
    s_mov_b64 exec, 1
    ds_write_b32 v12, v13 offset:4
    s_mov_b64 exec, -1
    s_branch a_kvgo
a_wlds:
    ds_read_b32 v16, v12 offset:4
    s_waitcnt lgkmcnt(0)
    v_readfirstlane_b32 s66, v16
    s_nop 0
    s_cmp_ge_u32 s66, 1
    s_cbranch_scc1 a_kvgo
    s_sleep 1
    s_branch a_wlds
a_kvgo:
a_qxw:
    ds_read_b32 v16, v12 offset:32
    s_waitcnt lgkmcnt(0)
    v_readfirstlane_b32 s66, v16
    s_nop 0
    s_cmp_ge_u32 s66, 24
    s_cbranch_scc0 a_qxw
    s_lshl_b32 s72, s75, 13
    s_lshl_b32 s73, s8, 10
    s_add_u32 s72, s72, s73
    s_add_u32 s73, s73, 0
    s_add_u32 m0, s73, 0
    s_nop 0
    buffer_load_dwordx4 v1, s[44:47], s72 offen sc1 lds
    s_add_u32 m0, s73, 8192
    s_add_u32 s72, s72, 8192
    s_and_b32 s72, s72, 0x1ffff
    buffer_load_dwordx4 v1, s[44:47], s72 offen sc1 lds
    s_add_u32 m0, s73, 16384
    s_add_u32 s72, s72, 8192
    s_and_b32 s72, s72, 0x1ffff
    buffer_load_dwordx4 v1, s[44:47], s72 offen sc1 lds
    s_mov_b32 s74, 0x6000
    s_waitcnt vmcnt(2)
    s_mov_b64 exec, 1
    ds_add_u32 v12, v13
    s_mov_b64 exec, -1
    s_cmp_eq_u32 s8, 0
    s_cbranch_scc0 a_w0
pf_kv2:
    buffer_load_dword v16, v15, s[40:43], s67 offen sc1
    s_waitcnt vmcnt(0)
    v_cmp_ne_u32 vcc, s15, v16
    s_nop 0
    s_cmp_eq_u64 vcc, 0
    s_cbranch_scc1 pf_kv2_ok
    s_sleep 2
    s_branch pf_kv2
pf_kv2_ok:
    v_mov_b32 v16, 2
    s_mov_b64 exec, 1
    ds_write_b32 v12, v16 offset:4
    s_mov_b64 exec, -1
a_w0:
    ds_read_b32 v14, v12
    s_waitcnt lgkmcnt(0)
    v_readfirstlane_b32 s70, v14
    s_nop 0
    s_cmp_ge_u32 s70, 8
    s_cbranch_scc0 a_w0
    s_mov_b32 s71, 16
rm_a:
    ds_read_b32 v14, v12 offset:48
    s_waitcnt lgkmcnt(0)
    v_readfirstlane_b32 s14, v14
    s_nop 0
    s_cmp_eq_u32 s14, 0
    s_cbranch_scc1 rm_a
    ds_read_b128 v[88:91], v8
    ds_read_b128 v[92:95], v8 offset:2048
    s_mov_b64 exec, s[64:65]
    ds_read_b128 v[96:99], v10
    ds_read_b128 v[100:103], v10 offset:512
    s_mov_b64 exec, -1
    s_waitcnt lgkmcnt(2)
    v_mfma_f32_32x32x16_bf16 v[16:31], v[88:91], v[4:7], 0
    v_mfma_f32_32x32x16_bf16 v[32:47], v[92:95], v[4:7], 0
    s_nop 7
    s_nop 3
    v_max3_f32 v15, v16, v17, v18
    v_max3_f32 v15, v15, v19, v20
    v_max3_f32 v15, v15, v21, v22
    v_max3_f32 v15, v15, v23, v24
    v_max3_f32 v15, v15, v25, v26
    v_max3_f32 v15, v15, v27, v28
    v_max3_f32 v15, v15, v29, v30
    v_max3_f32 v14, v31, v32, v33
    v_max3_f32 v14, v14, v34, v35
    v_max3_f32 v14, v14, v36, v37
    v_max3_f32 v14, v14, v38, v39
    v_max3_f32 v14, v14, v40, v41
    v_max3_f32 v14, v14, v42, v43
    v_max3_f32 v14, v14, v44, v45
    v_max3_f32 v14, v14, v46, v47
    v_max_f32 v15, v15, v14
    v_mov_b32 v14, v15
    s_nop 1
    v_permlane32_swap_b32 v15, v14
    s_nop 0
    v_max_f32 v15, v15, v14
    v_add_f32 v15, 0x42c40000, v15
    v_sub_f32 v72, 0, v15
    v_sub_f32 v73, 0, v15
    v_sub_f32 v74, 0, v15
    v_sub_f32 v75, 0, v15
    v_sub_f32 v76, 0, v15
    v_sub_f32 v77, 0, v15
    v_sub_f32 v78, 0, v15
    v_sub_f32 v79, 0, v15
    v_sub_f32 v80, 0, v15
    v_sub_f32 v81, 0, v15
    v_sub_f32 v82, 0, v15
    v_sub_f32 v83, 0, v15
    v_sub_f32 v84, 0, v15
    v_sub_f32 v85, 0, v15
    v_sub_f32 v86, 0, v15
    v_sub_f32 v87, 0, v15
    s_nop 1
    v_mfma_f32_32x32x16_bf16 v[16:31], v[88:91], v[4:7], v[72:87]
    s_mov_b32 s12, 8
    s_nop 7
    s_nop 1
a_wall:
    ds_read_b32 v14, v12 offset:4
    s_waitcnt lgkmcnt(0)
    v_readfirstlane_b32 s66, v14
    s_nop 0
    s_cmp_ge_u32 s66, 2
    s_cbranch_scc0 a_wall
.p2align 6
a_loop:
    s_setprio 3
    s_waitcnt lgkmcnt(0)
    s_waitcnt vmcnt(1)
    s_mov_b64 exec, 1
    ds_add_u32 v12, v13
    s_mov_b64 exec, -1
    v_exp_f32 v16, v16
    v_mfma_f32_32x32x16_bf16 v[56:71], v[108:111], v[52:55], v[56:71]
    v_exp_f32 v17, v17
    v_exp_f32 v18, v18
    v_exp_f32 v19, v19
    v_exp_f32 v20, v20
    v_mfma_f32_32x32x16_bf16 v[32:47], v[92:95], v[4:7], v[72:87]
    v_exp_f32 v21, v21
    v_exp_f32 v22, v22
    v_exp_f32 v23, v23
    s_mov_b64 exec, s[64:65]
    ds_read_b128 v[104:107], v10 offset:2048
    ds_read_b128 v[108:111], v10 offset:2560
    s_mov_b64 exec, -1
    v_exp_f32 v24, v24
    v_exp_f32 v25, v25
    v_exp_f32 v26, v26
    v_exp_f32 v27, v27
    v_cvt_pk_bf16_f32 v48, v16, v17
    v_cvt_pk_bf16_f32 v49, v18, v19
    v_cvt_pk_bf16_f32 v50, v20, v21
    v_cvt_pk_bf16_f32 v51, v22, v23
    v_exp_f32 v28, v28
    v_exp_f32 v29, v29
    v_mfma_f32_32x32x16_bf16 v[56:71], v[96:99], v[48:51], v[56:71]
    ds_read_b128 v[88:91], v8 offset:4096
    v_exp_f32 v30, v30
    v_exp_f32 v31, v31
    v_cvt_pk_bf16_f32 v52, v24, v25
    v_cvt_pk_bf16_f32 v53, v26, v27
    v_cvt_pk_bf16_f32 v54, v28, v29
    v_cvt_pk_bf16_f32 v55, v30, v31
    s_setprio 2
    s_waitcnt lgkmcnt(0)
    v_exp_f32 v32, v32
    v_mfma_f32_32x32x16_bf16 v[56:71], v[100:103], v[52:55], v[56:71]
    v_exp_f32 v33, v33
    v_exp_f32 v34, v34
    v_exp_f32 v35, v35
    v_exp_f32 v36, v36
    v_mfma_f32_32x32x16_bf16 v[16:31], v[88:91], v[4:7], v[72:87]
    v_exp_f32 v37, v37
    v_exp_f32 v38, v38
    v_exp_f32 v39, v39
    s_mov_b64 exec, s[64:65]
    ds_read_b128 v[96:99], v10 offset:4096
    ds_read_b128 v[100:103], v10 offset:4608
    s_mov_b64 exec, -1
    v_exp_f32 v40, v40
    v_exp_f32 v41, v41
    v_exp_f32 v42, v42
    v_exp_f32 v43, v43
    v_cvt_pk_bf16_f32 v48, v32, v33
    v_cvt_pk_bf16_f32 v49, v34, v35
    v_cvt_pk_bf16_f32 v50, v36, v37
    v_cvt_pk_bf16_f32 v51, v38, v39
    v_exp_f32 v44, v44
    v_exp_f32 v45, v45
    v_mfma_f32_32x32x16_bf16 v[56:71], v[104:107], v[48:51], v[56:71]
    ds_read_b128 v[92:95], v8 offset:6144
    ds_read_b32 v14, v12
    v_xor_b32 v8, 16384, v8
    v_exp_f32 v46, v46
    v_exp_f32 v47, v47
    v_cvt_pk_bf16_f32 v52, v40, v41
    v_cvt_pk_bf16_f32 v53, v42, v43
    v_cvt_pk_bf16_f32 v54, v44, v45
    v_cvt_pk_bf16_f32 v55, v46, v47
    s_setprio 1
    s_waitcnt lgkmcnt(0)
    v_exp_f32 v16, v16
    v_readfirstlane_b32 s70, v14
    v_mfma_f32_32x32x16_bf16 v[56:71], v[108:111], v[52:55], v[56:71]
    v_exp_f32 v17, v17
    s_cmp_ge_u32 s70, s71
    s_cbranch_scc1 a_ok2_0
a_spin2_0:
    s_sleep 1
    ds_read_b32 v14, v12
    s_waitcnt lgkmcnt(0)
    v_readfirstlane_b32 s70, v14
    s_nop 0
    s_cmp_ge_u32 s70, s71
    s_cbranch_scc0 a_spin2_0
a_ok2_0:
    s_add_u32 s71, s71, 8
    s_add_u32 m0, s73, s74
    s_add_u32 s72, s72, 8192
    s_and_b32 s72, s72, 0x1ffff
    buffer_load_dwordx4 v1, s[44:47], s72 offen sc1 lds
    s_add_u32 s74, s74, 8192
    s_and_b32 s74, s74, 0x7fff
    v_exp_f32 v18, v18
    v_exp_f32 v19, v19
    v_exp_f32 v20, v20
    v_mfma_f32_32x32x16_bf16 v[32:47], v[92:95], v[4:7], v[72:87]
    v_exp_f32 v21, v21
    v_exp_f32 v22, v22
    v_exp_f32 v23, v23
    s_mov_b64 exec, s[64:65]
    ds_read_b128 v[104:107], v10 offset:6144
    ds_read_b128 v[108:111], v10 offset:6656
    s_mov_b64 exec, -1
    v_xor_b32 v10, 16384, v10
    v_exp_f32 v24, v24
    v_exp_f32 v25, v25
    v_exp_f32 v26, v26
    v_exp_f32 v27, v27
    v_cvt_pk_bf16_f32 v48, v16, v17
    v_cvt_pk_bf16_f32 v49, v18, v19
    v_cvt_pk_bf16_f32 v50, v20, v21
    v_cvt_pk_bf16_f32 v51, v22, v23
    v_exp_f32 v28, v28
    v_exp_f32 v29, v29
    v_mfma_f32_32x32x16_bf16 v[56:71], v[96:99], v[48:51], v[56:71]
    ds_read_b128 v[88:91], v9 offset:0
    v_exp_f32 v30, v30
    v_exp_f32 v31, v31
    v_cvt_pk_bf16_f32 v52, v24, v25
    v_cvt_pk_bf16_f32 v53, v26, v27
    v_cvt_pk_bf16_f32 v54, v28, v29
    v_cvt_pk_bf16_f32 v55, v30, v31
    s_setprio 0
    s_waitcnt lgkmcnt(0)
    v_exp_f32 v32, v32
    v_mfma_f32_32x32x16_bf16 v[56:71], v[100:103], v[52:55], v[56:71]
    v_exp_f32 v33, v33
    v_exp_f32 v34, v34
    v_exp_f32 v35, v35
    v_exp_f32 v36, v36
    v_mfma_f32_32x32x16_bf16 v[16:31], v[88:91], v[4:7], v[72:87]
    v_exp_f32 v37, v37
    v_exp_f32 v38, v38
    v_exp_f32 v39, v39
    s_mov_b64 exec, s[64:65]
    ds_read_b128 v[96:99], v11 offset:0
    ds_read_b128 v[100:103], v11 offset:512
    s_mov_b64 exec, -1
    v_exp_f32 v40, v40
    v_exp_f32 v41, v41
    v_exp_f32 v42, v42
    v_exp_f32 v43, v43
    v_cvt_pk_bf16_f32 v48, v32, v33
    v_cvt_pk_bf16_f32 v49, v34, v35
    v_cvt_pk_bf16_f32 v50, v36, v37
    v_cvt_pk_bf16_f32 v51, v38, v39
    v_exp_f32 v44, v44
    v_exp_f32 v45, v45
    v_mfma_f32_32x32x16_bf16 v[56:71], v[104:107], v[48:51], v[56:71]
    ds_read_b128 v[92:95], v9 offset:2048
    v_exp_f32 v46, v46
    v_exp_f32 v47, v47
    v_cvt_pk_bf16_f32 v52, v40, v41
    v_cvt_pk_bf16_f32 v53, v42, v43
    v_cvt_pk_bf16_f32 v54, v44, v45
    v_cvt_pk_bf16_f32 v55, v46, v47
    s_setprio 3
    s_waitcnt lgkmcnt(0)
    s_waitcnt vmcnt(1)
    s_mov_b64 exec, 1
    ds_add_u32 v12, v13
    s_mov_b64 exec, -1
    v_exp_f32 v16, v16
    v_mfma_f32_32x32x16_bf16 v[56:71], v[108:111], v[52:55], v[56:71]
    v_exp_f32 v17, v17
    v_exp_f32 v18, v18
    v_exp_f32 v19, v19
    v_exp_f32 v20, v20
    v_mfma_f32_32x32x16_bf16 v[32:47], v[92:95], v[4:7], v[72:87]
    v_exp_f32 v21, v21
    v_exp_f32 v22, v22
    v_exp_f32 v23, v23
    s_mov_b64 exec, s[64:65]
    ds_read_b128 v[104:107], v11 offset:2048
    ds_read_b128 v[108:111], v11 offset:2560
    s_mov_b64 exec, -1
    v_exp_f32 v24, v24
    v_exp_f32 v25, v25
    v_exp_f32 v26, v26
    v_exp_f32 v27, v27
    v_cvt_pk_bf16_f32 v48, v16, v17
    v_cvt_pk_bf16_f32 v49, v18, v19
    v_cvt_pk_bf16_f32 v50, v20, v21
    v_cvt_pk_bf16_f32 v51, v22, v23
    v_exp_f32 v28, v28
    v_exp_f32 v29, v29
    v_mfma_f32_32x32x16_bf16 v[56:71], v[96:99], v[48:51], v[56:71]
    ds_read_b128 v[88:91], v9 offset:4096
    v_exp_f32 v30, v30
    v_exp_f32 v31, v31
    v_cvt_pk_bf16_f32 v52, v24, v25
    v_cvt_pk_bf16_f32 v53, v26, v27
    v_cvt_pk_bf16_f32 v54, v28, v29
    v_cvt_pk_bf16_f32 v55, v30, v31
    s_setprio 2
    s_waitcnt lgkmcnt(0)
    v_exp_f32 v32, v32
    v_mfma_f32_32x32x16_bf16 v[56:71], v[100:103], v[52:55], v[56:71]
    v_exp_f32 v33, v33
    v_exp_f32 v34, v34
    v_exp_f32 v35, v35
    v_exp_f32 v36, v36
    v_mfma_f32_32x32x16_bf16 v[16:31], v[88:91], v[4:7], v[72:87]
    v_exp_f32 v37, v37
    v_exp_f32 v38, v38
    v_exp_f32 v39, v39
    s_mov_b64 exec, s[64:65]
    ds_read_b128 v[96:99], v11 offset:4096
    ds_read_b128 v[100:103], v11 offset:4608
    s_mov_b64 exec, -1
    v_exp_f32 v40, v40
    v_exp_f32 v41, v41
    v_exp_f32 v42, v42
    v_exp_f32 v43, v43
    v_cvt_pk_bf16_f32 v48, v32, v33
    v_cvt_pk_bf16_f32 v49, v34, v35
    v_cvt_pk_bf16_f32 v50, v36, v37
    v_cvt_pk_bf16_f32 v51, v38, v39
    v_exp_f32 v44, v44
    v_exp_f32 v45, v45
    v_mfma_f32_32x32x16_bf16 v[56:71], v[104:107], v[48:51], v[56:71]
    ds_read_b128 v[92:95], v9 offset:6144
    ds_read_b32 v14, v12
    v_xor_b32 v9, 16384, v9
    v_exp_f32 v46, v46
    v_exp_f32 v47, v47
    v_cvt_pk_bf16_f32 v52, v40, v41
    v_cvt_pk_bf16_f32 v53, v42, v43
    v_cvt_pk_bf16_f32 v54, v44, v45
    v_cvt_pk_bf16_f32 v55, v46, v47
    s_setprio 1
    s_waitcnt lgkmcnt(0)
    v_exp_f32 v16, v16
    v_readfirstlane_b32 s70, v14
    v_mfma_f32_32x32x16_bf16 v[56:71], v[108:111], v[52:55], v[56:71]
    v_exp_f32 v17, v17
    s_cmp_ge_u32 s70, s71
    s_cbranch_scc1 a_ok6_0
a_spin6_0:
    s_sleep 1
    ds_read_b32 v14, v12
    s_waitcnt lgkmcnt(0)
    v_readfirstlane_b32 s70, v14
    s_nop 0
    s_cmp_ge_u32 s70, s71
    s_cbranch_scc0 a_spin6_0
a_ok6_0:
    s_add_u32 s71, s71, 8
    s_add_u32 m0, s73, s74
    s_add_u32 s72, s72, 8192
    s_and_b32 s72, s72, 0x1ffff
    buffer_load_dwordx4 v1, s[44:47], s72 offen sc1 lds
    s_add_u32 s74, s74, 8192
    s_and_b32 s74, s74, 0x7fff
    v_exp_f32 v18, v18
    v_exp_f32 v19, v19
    v_exp_f32 v20, v20
    v_mfma_f32_32x32x16_bf16 v[32:47], v[92:95], v[4:7], v[72:87]
    v_exp_f32 v21, v21
    v_exp_f32 v22, v22
    v_exp_f32 v23, v23
    s_mov_b64 exec, s[64:65]
    ds_read_b128 v[104:107], v11 offset:6144
    ds_read_b128 v[108:111], v11 offset:6656
    s_mov_b64 exec, -1
    v_xor_b32 v11, 16384, v11
    v_exp_f32 v24, v24
    v_exp_f32 v25, v25
    v_exp_f32 v26, v26
    v_exp_f32 v27, v27
    v_cvt_pk_bf16_f32 v48, v16, v17
    v_cvt_pk_bf16_f32 v49, v18, v19
    v_cvt_pk_bf16_f32 v50, v20, v21
    v_cvt_pk_bf16_f32 v51, v22, v23
    v_exp_f32 v28, v28
    v_exp_f32 v29, v29
    v_mfma_f32_32x32x16_bf16 v[56:71], v[96:99], v[48:51], v[56:71]
    ds_read_b128 v[88:91], v8 offset:0
    v_exp_f32 v30, v30
    v_exp_f32 v31, v31
    v_cvt_pk_bf16_f32 v52, v24, v25
    v_cvt_pk_bf16_f32 v53, v26, v27
    v_cvt_pk_bf16_f32 v54, v28, v29
    v_cvt_pk_bf16_f32 v55, v30, v31
    s_setprio 0
    s_waitcnt lgkmcnt(0)
    v_exp_f32 v32, v32
    v_mfma_f32_32x32x16_bf16 v[56:71], v[100:103], v[52:55], v[56:71]
    v_exp_f32 v33, v33
    v_exp_f32 v34, v34
    v_exp_f32 v35, v35
    v_exp_f32 v36, v36
    v_mfma_f32_32x32x16_bf16 v[16:31], v[88:91], v[4:7], v[72:87]
    v_exp_f32 v37, v37
    v_exp_f32 v38, v38
    v_exp_f32 v39, v39
    s_mov_b64 exec, s[64:65]
    ds_read_b128 v[96:99], v10 offset:0
    ds_read_b128 v[100:103], v10 offset:512
    s_mov_b64 exec, -1
    v_exp_f32 v40, v40
    v_exp_f32 v41, v41
    v_exp_f32 v42, v42
    v_exp_f32 v43, v43
    v_cvt_pk_bf16_f32 v48, v32, v33
    v_cvt_pk_bf16_f32 v49, v34, v35
    v_cvt_pk_bf16_f32 v50, v36, v37
    v_cvt_pk_bf16_f32 v51, v38, v39
    v_exp_f32 v44, v44
    v_exp_f32 v45, v45
    v_mfma_f32_32x32x16_bf16 v[56:71], v[104:107], v[48:51], v[56:71]
    ds_read_b128 v[92:95], v8 offset:2048
    v_exp_f32 v46, v46
    v_exp_f32 v47, v47
    v_cvt_pk_bf16_f32 v52, v40, v41
    v_cvt_pk_bf16_f32 v53, v42, v43
    v_cvt_pk_bf16_f32 v54, v44, v45
    v_cvt_pk_bf16_f32 v55, v46, v47
    s_sub_u32 s12, s12, 1
    s_cmp_lg_u32 s12, 0
    s_cbranch_scc1 a_loop
a_epi:
    s_setprio 3
    v_mfma_f32_32x32x16_bf16 v[56:71], v[108:111], v[52:55], v[56:71]
    s_mov_b32 s13, 0
a_fin:
    s_waitcnt vmcnt(0) lgkmcnt(0)
    s_nop 7
    s_nop 3
    v_mul_f32 v15, 0, v56
    v_fma_f32 v15, v57, 0, v15
    v_fma_f32 v15, v58, 0, v15
    v_fma_f32 v15, v59, 0, v15
    v_fma_f32 v15, v60, 0, v15
    v_fma_f32 v15, v61, 0, v15
    v_fma_f32 v15, v62, 0, v15
    v_fma_f32 v15, v63, 0, v15
    v_fma_f32 v15, v64, 0, v15
    v_max3_f32 v14, abs(v56), abs(v57), abs(v58)
    v_max3_f32 v14, v14, abs(v59), abs(v60)
    v_max3_f32 v14, v14, abs(v61), abs(v62)
    v_max_f32 v14, v14, abs(v63)
    v_cmp_u_f32 vcc, v15, v15
    s_mov_b32 s66, 0xc000000
    v_cmp_gt_f32 s[68:69], s66, v14
    s_cmp_lg_u32 s13, 0
    s_cbranch_scc1 a_norm
    s_nop 1
    s_or_b64 vcc, vcc, s[68:69]
    s_cmp_lg_u64 vcc, 0
    s_cbranch_scc1 a_fallback
a_norm:
    v_rcp_f32 v15, v64
    s_lshl_b32 s66, s7, 1
    s_add_u32 s66, s66, s9
    s_lshl_b32 s66, s66, 5
    s_lshl_b32 s67, s6, 2
    s_add_u32 s66, s66, s67
    s_add_u32 s66, s66, s10
    s_lshl_b32 s66, s66, 10
    s_add_u32 s66, s66, 7340032
    v_mul_f32 v56, v56, v15
    v_mul_f32 v57, v57, v15
    v_mul_f32 v58, v58, v15
    v_mul_f32 v59, v59, v15
    v_mul_f32 v60, v60, v15
    v_mul_f32 v61, v61, v15
    v_mul_f32 v62, v62, v15
    v_mul_f32 v63, v63, v15
    v_cvt_pk_bf16_f32 v48, v56, v57
    v_cvt_pk_bf16_f32 v49, v58, v59
    v_cvt_pk_bf16_f32 v50, v60, v61
    v_cvt_pk_bf16_f32 v51, v62, v63
    s_cmp_eq_u32 s14, 2
    s_cbranch_scc1 st_o_f
    buffer_store_dwordx4 v[48:51], v1, s[40:43], s66 offen sc0 sc1
    s_branch st_o_j
st_o_f:
    buffer_store_dwordx4 v[48:51], v1, s[40:43], s66 offen
st_o_j:
    s_lshl_b32 s67, s7, 10
    s_lshl_b32 s68, s6, 2
    s_add_u32 s67, s67, s68
    s_add_u32 s67, s67, 327680
    v_lshlrev_b32 v16, 7, v0
    v_mov_b32 v14, s15
    s_waitcnt vmcnt(0)
    s_mov_b64 exec, 1
    ds_add_rtn_u32 v15, v12, v13 offset:8
    s_waitcnt lgkmcnt(0)
    v_readfirstlane_b32 s66, v15
    s_nop 0
    s_cmp_eq_u32 s66, 7
    s_cbranch_scc0 a_done
    s_mov_b64 exec, 0xff
    s_cmp_eq_u32 s14, 2
    s_cbranch_scc1 st_of_f
    buffer_store_dword v14, v16, s[40:43], s67 offen sc0 sc1
    s_branch st_of_j
st_of_f:
    buffer_store_dword v14, v16, s[40:43], s67 offen
st_of_j:
a_done:
    s_mov_b64 exec, -1
    s_endpgm
a_fallback:
    v_mov_b32 v15, 0xff800000
    s_mov_b32 s66, 0
a_fb1:
    buffer_load_dwordx4 v[88:91], v1, s[44:47], s66 offen sc1
    s_waitcnt vmcnt(0)
    v_mfma_f32_32x32x16_bf16 v[16:31], v[88:91], v[4:7], 0
    s_nop 7
    s_nop 3
    v_max3_f32 v15, v15, v16, v17
    v_max3_f32 v15, v15, v18, v19
    v_max3_f32 v15, v15, v20, v21
    v_max3_f32 v15, v15, v22, v23
    v_max3_f32 v15, v15, v24, v25
    v_max3_f32 v15, v15, v26, v27
    v_max3_f32 v15, v15, v28, v29
    v_max3_f32 v15, v15, v30, v31
    s_add_u32 s66, s66, 2048
    s_cmp_lt_u32 s66, 0x20000
    s_cbranch_scc1 a_fb1
    v_mov_b32 v14, v15
    s_nop 1
    v_permlane32_swap_b32 v15, v14
    s_nop 0
    v_max_f32 v15, v15, v14
    v_sub_f32 v72, 0, v15
    v_sub_f32 v73, 0, v15
    v_sub_f32 v74, 0, v15
    v_sub_f32 v75, 0, v15
    v_sub_f32 v76, 0, v15
    v_sub_f32 v77, 0, v15
    v_sub_f32 v78, 0, v15
    v_sub_f32 v79, 0, v15
    v_sub_f32 v80, 0, v15
    v_sub_f32 v81, 0, v15
    v_sub_f32 v82, 0, v15
    v_sub_f32 v83, 0, v15
    v_sub_f32 v84, 0, v15
    v_sub_f32 v85, 0, v15
    v_sub_f32 v86, 0, v15
    v_sub_f32 v87, 0, v15
    v_mov_b32 v56, 0
    v_mov_b32 v57, 0
    v_mov_b32 v58, 0
    v_mov_b32 v59, 0
    v_mov_b32 v60, 0
    v_mov_b32 v61, 0
    v_mov_b32 v62, 0
    v_mov_b32 v63, 0
    v_mov_b32 v64, 0
    v_mov_b32 v65, 0
    v_mov_b32 v66, 0
    v_mov_b32 v67, 0
    v_mov_b32 v68, 0
    v_mov_b32 v69, 0
    v_mov_b32 v70, 0
    v_mov_b32 v71, 0
    v_and_b32 v14, 15, v0
    v_lshlrev_b32 v14, 4, v14
    v_lshl_add_u32 v14, v3, 8, v14
    v_add_u32 v14, 1024, v14
    s_mov_b32 s66, 0
a_fb2:
    buffer_load_dwordx4 v[88:91], v1, s[44:47], s66 offen sc1
    s_mov_b64 exec, s[64:65]
    buffer_load_dwordx4 v[96:99], v14, s[44:47], s66 offen sc1
    buffer_load_dwordx4 v[100:103], v14, s[44:47], s66 offen offset:512 sc1
    s_mov_b64 exec, -1
    s_waitcnt vmcnt(0)
    v_mfma_f32_32x32x16_bf16 v[16:31], v[88:91], v[4:7], v[72:87]
    s_nop 7
    s_nop 3
    v_exp_f32 v16, v16
    v_exp_f32 v17, v17
    v_exp_f32 v18, v18
    v_exp_f32 v19, v19
    v_exp_f32 v20, v20
    v_exp_f32 v21, v21
    v_exp_f32 v22, v22
    v_exp_f32 v23, v23
    v_exp_f32 v24, v24
    v_exp_f32 v25, v25
    v_exp_f32 v26, v26
    v_exp_f32 v27, v27
    v_exp_f32 v28, v28
    v_exp_f32 v29, v29
    v_exp_f32 v30, v30
    v_exp_f32 v31, v31
    s_nop 0
    v_cvt_pk_bf16_f32 v48, v16, v17
    v_cvt_pk_bf16_f32 v49, v18, v19
    v_cvt_pk_bf16_f32 v50, v20, v21
    v_cvt_pk_bf16_f32 v51, v22, v23
    v_cvt_pk_bf16_f32 v52, v24, v25
    v_cvt_pk_bf16_f32 v53, v26, v27
    v_cvt_pk_bf16_f32 v54, v28, v29
    v_cvt_pk_bf16_f32 v55, v30, v31
    s_nop 1
    v_mfma_f32_32x32x16_bf16 v[56:71], v[96:99], v[48:51], v[56:71]
    v_mfma_f32_32x32x16_bf16 v[56:71], v[100:103], v[52:55], v[56:71]
    s_nop 7
    s_nop 3
    s_add_u32 s66, s66, 2048
    s_cmp_lt_u32 s66, 0x20000
    s_cbranch_scc1 a_fb2
    s_mov_b32 s13, 1
    s_branch a_fin
k_g:
    s_sub_u32 s9, s8, 8
    s_mov_b32 m0, s67
    s_add_u32 s67, s67, 1040
    buffer_load_dwordx4 v1, s[48:51], s66 offen lds
    s_add_u32 s66, s66, 1024
    s_lshl_b32 s66, s9, 16
    s_add_u32 s66, s66, 0x40000
    s_lshl_b32 s68, s6, 7
    s_add_u32 s66, s66, s68
    s_lshl_b32 s67, s9, 13
    s_add_u32 s67, s67, 32768
    s_cmp_eq_u32 s3, 1
    s_cselect_b32 s56, s22, s20
    s_cselect_b32 s57, s23, s21
    s_mov_b32 s58, 16384
    s_mov_b32 s59, 0x20000
    s_lshl_b32 s70, s9, 12
    s_add_u32 s71, s70, 132096
    s_mov_b32 m0, s71
    s_cmp_ge_u32 s3, 2
    s_cbranch_scc1 g_nokv
    buffer_load_dwordx4 v1, s[56:59], s70 offen offset:0 lds
    buffer_load_dwordx4 v1, s[56:59], s70 offen offset:1024 lds
    buffer_load_dwordx4 v1, s[56:59], s70 offen offset:2048 lds
    buffer_load_dwordx4 v1, s[56:59], s70 offen offset:3072 lds
g_nokv:
    s_mov_b32 m0, s67
    s_add_u32 s67, s67, 1024
    buffer_load_dwordx4 v4, s[52:55], s66 offen lds
    s_add_u32 s66, s66, 8192
    s_mov_b32 m0, s67
    s_add_u32 s67, s67, 1024
    buffer_load_dwordx4 v4, s[52:55], s66 offen lds
    s_add_u32 s66, s66, 8192
    s_mov_b32 m0, s67
    s_add_u32 s67, s67, 1024
    buffer_load_dwordx4 v4, s[52:55], s66 offen lds
    s_add_u32 s66, s66, 8192
    s_mov_b32 m0, s67
    s_add_u32 s67, s67, 1024
    buffer_load_dwordx4 v4, s[52:55], s66 offen lds
    s_add_u32 s66, s66, 8192
    s_mov_b32 m0, s67
    s_add_u32 s67, s67, 1024
    buffer_load_dwordx4 v4, s[52:55], s66 offen lds
    s_add_u32 s66, s66, 8192
    s_mov_b32 m0, s67
    s_add_u32 s67, s67, 1024
    buffer_load_dwordx4 v4, s[52:55], s66 offen lds
    s_add_u32 s66, s66, 8192
    s_mov_b32 m0, s67
    s_add_u32 s67, s67, 1024
    buffer_load_dwordx4 v4, s[52:55], s66 offen lds
    s_add_u32 s66, s66, 8192
    s_mov_b32 m0, s67
    s_add_u32 s67, s67, 1024
    buffer_load_dwordx4 v4, s[52:55], s66 offen lds
    s_add_u32 s66, s66, 8192
    s_mov_b32 s40, s38
    s_mov_b32 s41, s39
    s_mov_b32 s42, 10485760
    s_mov_b32 s43, 0x20000
    s_add_u32 s44, s38, 0
    s_addc_u32 s45, s39, 0
    s_mov_b32 s46, 0x20000
    s_mov_b32 s47, 0x20000
    s_mov_b32 s60, s36
    s_mov_b32 s61, s37
    s_mov_b32 s62, 256
    s_mov_b32 s63, 0x20000
    s_getpc_b64 s[76:77]
k_pcref:
    s_lshl_b32 s68, s9, 13
    v_lshlrev_b32 v10, 7, v0
    v_add_u32 v10, s68, v10
    v_add_u32 v10, recurrent_scan__grouped_kv_mqa__glu_gated_swiglu__prompt_kernel - k_pcref, v10
    s_mov_b32 s68, k_end - k_pcref - 4
    v_min_i32 v10, s68, v10
    v_mov_b32 v13, s77
    v_ashrrev_i32 v11, 31, v10
    v_add_co_u32 v12, vcc, s76, v10
    s_nop 1
    v_addc_co_u32 v13, vcc, v11, v13, vcc
    global_load_dword v163, v[12:13], off
    s_cmp_eq_u32 s9, 1
    s_cselect_b32 s70, s30, s28
    s_cselect_b32 s71, s31, s29
    s_cmp_eq_u32 s9, 2
    s_cselect_b32 s70, s32, s70
    s_cselect_b32 s71, s33, s71
    s_cmp_eq_u32 s9, 3
    s_cselect_b32 s70, s24, s70
    s_cselect_b32 s71, s25, s71
    s_cselect_b32 s72, 16, 43
    s_mul_i32 s73, s2, s72
    v_add_u32 v10, s73, v0
    v_lshlrev_b32 v10, 7, v10
    v_cmp_gt_u32 vcc, s72, v0
    s_nop 0
    s_and_b64 exec, exec, vcc
    global_load_dword v162, v10, s[70:71]
    s_mov_b64 exec, -1
    s_cmp_ge_u32 s3, 2
    s_cbranch_scc1 g_nokv2
    s_waitcnt vmcnt(10)
    s_branch g_kvj
g_nokv2:
    s_waitcnt vmcnt(10)
g_kvj:
    s_cmp_eq_u32 s9, 2
    s_cbranch_scc0 g_notlb
    v_mov_b32 v10, 0
    s_mov_b64 exec, 1
    global_load_dword v156, v10, s[28:29]
    global_load_dword v157, v10, s[30:31]
    global_load_dword v158, v10, s[32:33]
    global_load_dword v159, v10, s[24:25]
    global_load_dword v160, v10, s[34:35]
    s_mov_b64 exec, 0x1f
    v_lshlrev_b32 v10, 21, v0
    v_add_u32 v10, 0x100000, v10
    global_load_dword v161, v10, s[38:39]
    s_mov_b64 exec, -1
g_notlb:
    v_mov_b32 v9, 163776
    s_cmp_eq_u32 s9, 0
    s_cbranch_scc0 g_nz
    v_mov_b32 v10, 0
    v_mov_b32 v11, 0
    v_mov_b32 v12, 0
    v_mov_b32 v13, 0
    s_mov_b64 exec, 1
    ds_write_b128 v9, v[10:13]
    ds_write_b128 v9, v[10:13] offset:16
    ds_write_b128 v9, v[10:13] offset:32
    ds_write_b128 v9, v[10:13] offset:48
    s_mov_b64 exec, -1
g_nz:
    s_waitcnt lgkmcnt(0)
    s_add_u32 s15, s15, 1
    s_barrier
    s_cmp_eq_u32 s9, 3
    s_cbranch_scc0 g_noxp
    s_getreg_b32 s13, hwreg(HW_REG_XCC_ID)
    s_and_b32 s13, s13, 15
    s_lshl_b32 s66, s7, 10
    s_lshl_b32 s67, s6, 3
    s_add_u32 s66, s66, s67
    s_add_u32 s66, s66, 393216
    v_lshlrev_b32 v10, 7, v0
    v_mov_b32 v12, s15
    v_mov_b32 v13, s13
    s_mov_b64 exec, 0xff
    buffer_store_dwordx2 v[12:13], v10, s[40:43], s66 offen sc0 sc1
    s_mov_b64 exec, -1
g_noxp:
    s_cmp_lt_u32 s3, 2
    s_cbranch_scc1 g_kvprod
    s_cmp_eq_u32 s9, 2
    s_cbranch_scc1 g_b2w70
    s_cmp_eq_u32 s9, 3
    s_cbranch_scc0 g_b2w10
    s_waitcnt vmcnt(3)
    s_branch g_b2j0
g_b2w10:
    s_waitcnt vmcnt(2)
    s_branch g_b2j0
g_b2w70:
    s_waitcnt vmcnt(8)
g_b2j0:
    s_barrier
    v_mov_b32 v13, 1
    s_mov_b64 exec, 1
    ds_add_u32 v9, v13 offset:44
    s_mov_b64 exec, -1
    s_branch g_skipkv
g_kvprod:
    s_setprio 3
    s_and_b32 s10, s9, 1
    s_lshr_b32 s11, s9, 1
    v_bfe_u32 v20, v0, 2, 2
    v_and_b32 v21, 3, v0
    v_lshlrev_b32 v23, 8, v3
    v_lshl_add_u32 v23, v20, 5, v23
    v_lshl_add_u32 v23, v21, 3, v23
    s_lshl_b32 s66, s11, 13
    s_add_u32 s66, s66, 132096
    v_add_u32 v23, s66, v23
    v_mul_u32_u24 v7, 1040, v2
    v_lshl_add_u32 v7, v3, 4, v7
    s_mul_i32 s66, s10, 33280
    s_lshl_b32 s67, s11, 9
    s_add_u32 s66, s66, s67
    s_add_u32 s66, s66, 65536
    v_add_u32 v24, s66, v7
    v_mov_b32 v25, 0x3f803f80
    v_mov_b32 v26, 0
    v_mov_b32 v27, 0
    s_cmp_eq_u32 s3, 1
    s_cbranch_scc1 g_vchain
    ds_read_b64_tr_b16 v[80:81], v23 offset:0
    ds_read_b64_tr_b16 v[82:83], v23 offset:128
    ds_read_b128 v[84:87], v24 offset:0
    ds_read_b64_tr_b16 v[88:89], v23 offset:512
    ds_read_b64_tr_b16 v[90:91], v23 offset:640
    ds_read_b128 v[92:95], v24 offset:32
    ds_read_b64_tr_b16 v[96:97], v23 offset:1024
    ds_read_b64_tr_b16 v[98:99], v23 offset:1152
    ds_read_b128 v[100:103], v24 offset:64
    ds_read_b64_tr_b16 v[104:105], v23 offset:1536
    ds_read_b64_tr_b16 v[106:107], v23 offset:1664
    ds_read_b128 v[108:111], v24 offset:96
    s_waitcnt lgkmcnt(9)
    v_mfma_f32_32x32x16_bf16 v[64:79], v[80:83], v[84:87], 0
    v_dot2_f32_bf16 v26, v80, v25, v26
    v_dot2_f32_bf16 v27, v81, v25, v27
    v_dot2_f32_bf16 v26, v82, v25, v26
    v_dot2_f32_bf16 v27, v83, v25, v27
    ds_read_b64_tr_b16 v[80:81], v23 offset:2048
    ds_read_b64_tr_b16 v[82:83], v23 offset:2176
    ds_read_b128 v[84:87], v24 offset:128
    s_waitcnt lgkmcnt(9)
    v_mfma_f32_32x32x16_bf16 v[64:79], v[88:91], v[92:95], v[64:79]
    v_dot2_f32_bf16 v26, v88, v25, v26
    v_dot2_f32_bf16 v27, v89, v25, v27
    v_dot2_f32_bf16 v26, v90, v25, v26
    v_dot2_f32_bf16 v27, v91, v25, v27
    ds_read_b64_tr_b16 v[88:89], v23 offset:2560
    ds_read_b64_tr_b16 v[90:91], v23 offset:2688
    ds_read_b128 v[92:95], v24 offset:160
    s_waitcnt lgkmcnt(9)
    v_mfma_f32_32x32x16_bf16 v[64:79], v[96:99], v[100:103], v[64:79]
    v_dot2_f32_bf16 v26, v96, v25, v26
    v_dot2_f32_bf16 v27, v97, v25, v27
    v_dot2_f32_bf16 v26, v98, v25, v26
    v_dot2_f32_bf16 v27, v99, v25, v27
    ds_read_b64_tr_b16 v[96:97], v23 offset:3072
    ds_read_b64_tr_b16 v[98:99], v23 offset:3200
    ds_read_b128 v[100:103], v24 offset:192
    s_waitcnt lgkmcnt(9)
    v_mfma_f32_32x32x16_bf16 v[64:79], v[104:107], v[108:111], v[64:79]
    v_dot2_f32_bf16 v26, v104, v25, v26
    v_dot2_f32_bf16 v27, v105, v25, v27
    v_dot2_f32_bf16 v26, v106, v25, v26
    v_dot2_f32_bf16 v27, v107, v25, v27
    ds_read_b64_tr_b16 v[104:105], v23 offset:3584
    ds_read_b64_tr_b16 v[106:107], v23 offset:3712
    ds_read_b128 v[108:111], v24 offset:224
    s_waitcnt lgkmcnt(9)
    v_mfma_f32_32x32x16_bf16 v[64:79], v[80:83], v[84:87], v[64:79]
    v_dot2_f32_bf16 v26, v80, v25, v26
    v_dot2_f32_bf16 v27, v81, v25, v27
    v_dot2_f32_bf16 v26, v82, v25, v26
    v_dot2_f32_bf16 v27, v83, v25, v27
    ds_read_b64_tr_b16 v[80:81], v23 offset:4096
    ds_read_b64_tr_b16 v[82:83], v23 offset:4224
    ds_read_b128 v[84:87], v24 offset:256
    s_waitcnt lgkmcnt(9)
    v_mfma_f32_32x32x16_bf16 v[64:79], v[88:91], v[92:95], v[64:79]
    v_dot2_f32_bf16 v26, v88, v25, v26
    v_dot2_f32_bf16 v27, v89, v25, v27
    v_dot2_f32_bf16 v26, v90, v25, v26
    v_dot2_f32_bf16 v27, v91, v25, v27
    ds_read_b64_tr_b16 v[88:89], v23 offset:4608
    ds_read_b64_tr_b16 v[90:91], v23 offset:4736
    ds_read_b128 v[92:95], v24 offset:288
    s_waitcnt lgkmcnt(9)
    v_mfma_f32_32x32x16_bf16 v[64:79], v[96:99], v[100:103], v[64:79]
    v_dot2_f32_bf16 v26, v96, v25, v26
    v_dot2_f32_bf16 v27, v97, v25, v27
    v_dot2_f32_bf16 v26, v98, v25, v26
    v_dot2_f32_bf16 v27, v99, v25, v27
    ds_read_b64_tr_b16 v[96:97], v23 offset:5120
    ds_read_b64_tr_b16 v[98:99], v23 offset:5248
    ds_read_b128 v[100:103], v24 offset:320
    s_waitcnt lgkmcnt(9)
    v_mfma_f32_32x32x16_bf16 v[64:79], v[104:107], v[108:111], v[64:79]
    v_dot2_f32_bf16 v26, v104, v25, v26
    v_dot2_f32_bf16 v27, v105, v25, v27
    v_dot2_f32_bf16 v26, v106, v25, v26
    v_dot2_f32_bf16 v27, v107, v25, v27
    ds_read_b64_tr_b16 v[104:105], v23 offset:5632
    ds_read_b64_tr_b16 v[106:107], v23 offset:5760
    ds_read_b128 v[108:111], v24 offset:352
    s_waitcnt lgkmcnt(9)
    v_mfma_f32_32x32x16_bf16 v[64:79], v[80:83], v[84:87], v[64:79]
    v_dot2_f32_bf16 v26, v80, v25, v26
    v_dot2_f32_bf16 v27, v81, v25, v27
    v_dot2_f32_bf16 v26, v82, v25, v26
    v_dot2_f32_bf16 v27, v83, v25, v27
    s_cmp_eq_u32 s9, 2
    s_cbranch_scc1 g_b2w71
    s_cmp_eq_u32 s9, 3
    s_cbranch_scc0 g_b2w11
    s_waitcnt vmcnt(3)
    s_branch g_b2j1
g_b2w11:
    s_waitcnt vmcnt(2)
    s_branch g_b2j1
g_b2w71:
    s_waitcnt vmcnt(8)
g_b2j1:
    s_barrier
    ds_read_b64_tr_b16 v[80:81], v23 offset:6144
    ds_read_b64_tr_b16 v[82:83], v23 offset:6272
    ds_read_b128 v[84:87], v24 offset:384
    s_waitcnt lgkmcnt(9)
    v_mfma_f32_32x32x16_bf16 v[64:79], v[88:91], v[92:95], v[64:79]
    v_dot2_f32_bf16 v26, v88, v25, v26
    v_dot2_f32_bf16 v27, v89, v25, v27
    v_dot2_f32_bf16 v26, v90, v25, v26
    v_dot2_f32_bf16 v27, v91, v25, v27
    ds_read_b64_tr_b16 v[88:89], v23 offset:6656
    ds_read_b64_tr_b16 v[90:91], v23 offset:6784
    ds_read_b128 v[92:95], v24 offset:416
    s_waitcnt lgkmcnt(9)
    v_mfma_f32_32x32x16_bf16 v[64:79], v[96:99], v[100:103], v[64:79]
    v_dot2_f32_bf16 v26, v96, v25, v26
    v_dot2_f32_bf16 v27, v97, v25, v27
    v_dot2_f32_bf16 v26, v98, v25, v26
    v_dot2_f32_bf16 v27, v99, v25, v27
    ds_read_b64_tr_b16 v[96:97], v23 offset:7168
    ds_read_b64_tr_b16 v[98:99], v23 offset:7296
    ds_read_b128 v[100:103], v24 offset:448
    s_waitcnt lgkmcnt(9)
    v_mfma_f32_32x32x16_bf16 v[64:79], v[104:107], v[108:111], v[64:79]
    v_dot2_f32_bf16 v26, v104, v25, v26
    v_dot2_f32_bf16 v27, v105, v25, v27
    v_dot2_f32_bf16 v26, v106, v25, v26
    v_dot2_f32_bf16 v27, v107, v25, v27
    ds_read_b64_tr_b16 v[104:105], v23 offset:7680
    ds_read_b64_tr_b16 v[106:107], v23 offset:7808
    ds_read_b128 v[108:111], v24 offset:480
    s_waitcnt lgkmcnt(9)
    v_mfma_f32_32x32x16_bf16 v[64:79], v[80:83], v[84:87], v[64:79]
    v_dot2_f32_bf16 v26, v80, v25, v26
    v_dot2_f32_bf16 v27, v81, v25, v27
    v_dot2_f32_bf16 v26, v82, v25, v26
    v_dot2_f32_bf16 v27, v83, v25, v27
    s_waitcnt lgkmcnt(6)
    v_mfma_f32_32x32x16_bf16 v[64:79], v[88:91], v[92:95], v[64:79]
    v_dot2_f32_bf16 v26, v88, v25, v26
    v_dot2_f32_bf16 v27, v89, v25, v27
    v_dot2_f32_bf16 v26, v90, v25, v26
    v_dot2_f32_bf16 v27, v91, v25, v27
    s_waitcnt lgkmcnt(3)
    v_mfma_f32_32x32x16_bf16 v[64:79], v[96:99], v[100:103], v[64:79]
    v_dot2_f32_bf16 v26, v96, v25, v26
    v_dot2_f32_bf16 v27, v97, v25, v27
    v_dot2_f32_bf16 v26, v98, v25, v26
    v_dot2_f32_bf16 v27, v99, v25, v27
    s_waitcnt lgkmcnt(0)
    v_mfma_f32_32x32x16_bf16 v[64:79], v[104:107], v[108:111], v[64:79]
    v_dot2_f32_bf16 v26, v104, v25, v26
    v_dot2_f32_bf16 v27, v105, v25, v27
    v_dot2_f32_bf16 v26, v106, v25, v26
    v_dot2_f32_bf16 v27, v107, v25, v27
    s_branch g_kvdone
g_vchain:
    ds_read_b64_tr_b16 v[80:81], v23 offset:0
    ds_read_b64_tr_b16 v[82:83], v23 offset:128
    ds_read_b128 v[84:87], v24 offset:0
    ds_read_b64_tr_b16 v[88:89], v23 offset:512
    ds_read_b64_tr_b16 v[90:91], v23 offset:640
    ds_read_b128 v[92:95], v24 offset:32
    ds_read_b64_tr_b16 v[96:97], v23 offset:1024
    ds_read_b64_tr_b16 v[98:99], v23 offset:1152
    ds_read_b128 v[100:103], v24 offset:64
    ds_read_b64_tr_b16 v[104:105], v23 offset:1536
    ds_read_b64_tr_b16 v[106:107], v23 offset:1664
    ds_read_b128 v[108:111], v24 offset:96
    s_waitcnt lgkmcnt(9)
    v_mfma_f32_32x32x16_bf16 v[64:79], v[84:87], v[80:83], 0
    v_dot2_f32_bf16 v26, v80, v25, v26
    v_dot2_f32_bf16 v27, v81, v25, v27
    v_dot2_f32_bf16 v26, v82, v25, v26
    v_dot2_f32_bf16 v27, v83, v25, v27
    ds_read_b64_tr_b16 v[80:81], v23 offset:2048
    ds_read_b64_tr_b16 v[82:83], v23 offset:2176
    ds_read_b128 v[84:87], v24 offset:128
    s_waitcnt lgkmcnt(9)
    v_mfma_f32_32x32x16_bf16 v[64:79], v[92:95], v[88:91], v[64:79]
    v_dot2_f32_bf16 v26, v88, v25, v26
    v_dot2_f32_bf16 v27, v89, v25, v27
    v_dot2_f32_bf16 v26, v90, v25, v26
    v_dot2_f32_bf16 v27, v91, v25, v27
    ds_read_b64_tr_b16 v[88:89], v23 offset:2560
    ds_read_b64_tr_b16 v[90:91], v23 offset:2688
    ds_read_b128 v[92:95], v24 offset:160
    s_waitcnt lgkmcnt(9)
    v_mfma_f32_32x32x16_bf16 v[64:79], v[100:103], v[96:99], v[64:79]
    v_dot2_f32_bf16 v26, v96, v25, v26
    v_dot2_f32_bf16 v27, v97, v25, v27
    v_dot2_f32_bf16 v26, v98, v25, v26
    v_dot2_f32_bf16 v27, v99, v25, v27
    ds_read_b64_tr_b16 v[96:97], v23 offset:3072
    ds_read_b64_tr_b16 v[98:99], v23 offset:3200
    ds_read_b128 v[100:103], v24 offset:192
    s_waitcnt lgkmcnt(9)
    v_mfma_f32_32x32x16_bf16 v[64:79], v[108:111], v[104:107], v[64:79]
    v_dot2_f32_bf16 v26, v104, v25, v26
    v_dot2_f32_bf16 v27, v105, v25, v27
    v_dot2_f32_bf16 v26, v106, v25, v26
    v_dot2_f32_bf16 v27, v107, v25, v27
    ds_read_b64_tr_b16 v[104:105], v23 offset:3584
    ds_read_b64_tr_b16 v[106:107], v23 offset:3712
    ds_read_b128 v[108:111], v24 offset:224
    s_waitcnt lgkmcnt(9)
    v_mfma_f32_32x32x16_bf16 v[64:79], v[84:87], v[80:83], v[64:79]
    v_dot2_f32_bf16 v26, v80, v25, v26
    v_dot2_f32_bf16 v27, v81, v25, v27
    v_dot2_f32_bf16 v26, v82, v25, v26
    v_dot2_f32_bf16 v27, v83, v25, v27
    ds_read_b64_tr_b16 v[80:81], v23 offset:4096
    ds_read_b64_tr_b16 v[82:83], v23 offset:4224
    ds_read_b128 v[84:87], v24 offset:256
    s_waitcnt lgkmcnt(9)
    v_mfma_f32_32x32x16_bf16 v[64:79], v[92:95], v[88:91], v[64:79]
    v_dot2_f32_bf16 v26, v88, v25, v26
    v_dot2_f32_bf16 v27, v89, v25, v27
    v_dot2_f32_bf16 v26, v90, v25, v26
    v_dot2_f32_bf16 v27, v91, v25, v27
    ds_read_b64_tr_b16 v[88:89], v23 offset:4608
    ds_read_b64_tr_b16 v[90:91], v23 offset:4736
    ds_read_b128 v[92:95], v24 offset:288
    s_waitcnt lgkmcnt(9)
    v_mfma_f32_32x32x16_bf16 v[64:79], v[100:103], v[96:99], v[64:79]
    v_dot2_f32_bf16 v26, v96, v25, v26
    v_dot2_f32_bf16 v27, v97, v25, v27
    v_dot2_f32_bf16 v26, v98, v25, v26
    v_dot2_f32_bf16 v27, v99, v25, v27
    ds_read_b64_tr_b16 v[96:97], v23 offset:5120
    ds_read_b64_tr_b16 v[98:99], v23 offset:5248
    ds_read_b128 v[100:103], v24 offset:320
    s_waitcnt lgkmcnt(9)
    v_mfma_f32_32x32x16_bf16 v[64:79], v[108:111], v[104:107], v[64:79]
    v_dot2_f32_bf16 v26, v104, v25, v26
    v_dot2_f32_bf16 v27, v105, v25, v27
    v_dot2_f32_bf16 v26, v106, v25, v26
    v_dot2_f32_bf16 v27, v107, v25, v27
    ds_read_b64_tr_b16 v[104:105], v23 offset:5632
    ds_read_b64_tr_b16 v[106:107], v23 offset:5760
    ds_read_b128 v[108:111], v24 offset:352
    s_waitcnt lgkmcnt(9)
    v_mfma_f32_32x32x16_bf16 v[64:79], v[84:87], v[80:83], v[64:79]
    v_dot2_f32_bf16 v26, v80, v25, v26
    v_dot2_f32_bf16 v27, v81, v25, v27
    v_dot2_f32_bf16 v26, v82, v25, v26
    v_dot2_f32_bf16 v27, v83, v25, v27
    s_cmp_eq_u32 s9, 2
    s_cbranch_scc1 g_b2w72
    s_cmp_eq_u32 s9, 3
    s_cbranch_scc0 g_b2w12
    s_waitcnt vmcnt(3)
    s_branch g_b2j2
g_b2w12:
    s_waitcnt vmcnt(2)
    s_branch g_b2j2
g_b2w72:
    s_waitcnt vmcnt(8)
g_b2j2:
    s_barrier
    ds_read_b64_tr_b16 v[80:81], v23 offset:6144
    ds_read_b64_tr_b16 v[82:83], v23 offset:6272
    ds_read_b128 v[84:87], v24 offset:384
    s_waitcnt lgkmcnt(9)
    v_mfma_f32_32x32x16_bf16 v[64:79], v[92:95], v[88:91], v[64:79]
    v_dot2_f32_bf16 v26, v88, v25, v26
    v_dot2_f32_bf16 v27, v89, v25, v27
    v_dot2_f32_bf16 v26, v90, v25, v26
    v_dot2_f32_bf16 v27, v91, v25, v27
    ds_read_b64_tr_b16 v[88:89], v23 offset:6656
    ds_read_b64_tr_b16 v[90:91], v23 offset:6784
    ds_read_b128 v[92:95], v24 offset:416
    s_waitcnt lgkmcnt(9)
    v_mfma_f32_32x32x16_bf16 v[64:79], v[100:103], v[96:99], v[64:79]
    v_dot2_f32_bf16 v26, v96, v25, v26
    v_dot2_f32_bf16 v27, v97, v25, v27
    v_dot2_f32_bf16 v26, v98, v25, v26
    v_dot2_f32_bf16 v27, v99, v25, v27
    ds_read_b64_tr_b16 v[96:97], v23 offset:7168
    ds_read_b64_tr_b16 v[98:99], v23 offset:7296
    ds_read_b128 v[100:103], v24 offset:448
    s_waitcnt lgkmcnt(9)
    v_mfma_f32_32x32x16_bf16 v[64:79], v[108:111], v[104:107], v[64:79]
    v_dot2_f32_bf16 v26, v104, v25, v26
    v_dot2_f32_bf16 v27, v105, v25, v27
    v_dot2_f32_bf16 v26, v106, v25, v26
    v_dot2_f32_bf16 v27, v107, v25, v27
    ds_read_b64_tr_b16 v[104:105], v23 offset:7680
    ds_read_b64_tr_b16 v[106:107], v23 offset:7808
    ds_read_b128 v[108:111], v24 offset:480
    s_waitcnt lgkmcnt(9)
    v_mfma_f32_32x32x16_bf16 v[64:79], v[84:87], v[80:83], v[64:79]
    v_dot2_f32_bf16 v26, v80, v25, v26
    v_dot2_f32_bf16 v27, v81, v25, v27
    v_dot2_f32_bf16 v26, v82, v25, v26
    v_dot2_f32_bf16 v27, v83, v25, v27
    s_waitcnt lgkmcnt(6)
    v_mfma_f32_32x32x16_bf16 v[64:79], v[92:95], v[88:91], v[64:79]
    v_dot2_f32_bf16 v26, v88, v25, v26
    v_dot2_f32_bf16 v27, v89, v25, v27
    v_dot2_f32_bf16 v26, v90, v25, v26
    v_dot2_f32_bf16 v27, v91, v25, v27
    s_waitcnt lgkmcnt(3)
    v_mfma_f32_32x32x16_bf16 v[64:79], v[100:103], v[96:99], v[64:79]
    v_dot2_f32_bf16 v26, v96, v25, v26
    v_dot2_f32_bf16 v27, v97, v25, v27
    v_dot2_f32_bf16 v26, v98, v25, v26
    v_dot2_f32_bf16 v27, v99, v25, v27
    s_waitcnt lgkmcnt(0)
    v_mfma_f32_32x32x16_bf16 v[64:79], v[108:111], v[104:107], v[64:79]
    v_dot2_f32_bf16 v26, v104, v25, v26
    v_dot2_f32_bf16 v27, v105, v25, v27
    v_dot2_f32_bf16 v26, v106, v25, v26
    v_dot2_f32_bf16 v27, v107, v25, v27
g_kvdone:
    v_mov_b32 v13, 1
    s_mov_b64 exec, 1
    ds_add_u32 v9, v13 offset:36
    s_mov_b64 exec, -1
    s_nop 2
    v_add_f32 v26, v26, v27
    v_mov_b32 v27, v26
    s_nop 1
    v_permlane32_swap_b32 v26, v27
    s_mul_i32 s66, s10, 4352
    s_add_u32 s66, s66, 148480
    v_add_u32 v14, s66, v1
    v_add_f32 v26, v26, v27
    v_lshlrev_b32 v12, 2, v2
    v_add_u32 v12, s66, v12
    s_lshl_b32 s67, s10, 2
    v_add_u32 v15, s67, v9
    v_mov_b32 v13, 1
    s_cmp_eq_u32 s11, 0
    s_cbranch_scc1 g_kvrecv
    ds_write_b128 v14, v[64:67] offset:0
    ds_write_b128 v14, v[68:71] offset:1024
    ds_write_b128 v14, v[72:75] offset:2048
    ds_write_b128 v14, v[76:79] offset:3072
    ds_write_b32 v12, v26 offset:4096
    s_waitcnt lgkmcnt(0)
    s_mov_b64 exec, 1
    ds_write_b32 v15, v13 offset:16
    s_mov_b64 exec, -1
    s_mov_b64 exec, 1
    ds_add_u32 v9, v13 offset:44
    s_mov_b64 exec, -1
    s_branch g_skipkv
g_kvrecv:
    s_lshl_b32 s66, s10, 10
    s_add_u32 s66, s66, 159744
    v_lshlrev_b32 v28, 3, v2
    v_add_u32 v28, s66, v28
    ds_read_b64 v[32:33], v28 offset:0
    ds_read_b64 v[34:35], v28 offset:256
    ds_read_b64 v[36:37], v28 offset:512
    ds_read_b64 v[38:39], v28 offset:768
    s_waitcnt lgkmcnt(0)
    v_add_f32 v32, v32, v34
    v_add_f32 v33, v33, v35
    v_add_f32 v36, v36, v38
    v_add_f32 v37, v37, v39
    v_add_f32 v32, v32, v36
    v_add_f32 v33, v33, v37
    v_mul_f32 v32, 0x3b000000, v32
    v_mul_f32 v33, 0x3b000000, v33
    v_fma_f32 v33, -v32, v32, v33
    v_max_f32 v33, 0, v33
    v_add_f32 v33, 0x3727c5ac, v33
    v_rsq_f32 v33, v33
g_kvspin:
    ds_read_b32 v29, v15 offset:16
    s_waitcnt lgkmcnt(0)
    v_readfirstlane_b32 s66, v29
    s_nop 0
    s_cmp_eq_u32 s66, 1
    s_cbranch_scc0 g_kvspin
    ds_read_b128 v[80:83], v14 offset:0
    ds_read_b128 v[84:87], v14 offset:1024
    ds_read_b128 v[88:91], v14 offset:2048
    ds_read_b128 v[92:95], v14 offset:3072
    ds_read_b32 v27, v12 offset:4096
    s_lshl_b32 s66, s10, 9
    s_add_u32 s66, s66, 162304
    v_lshlrev_b32 v28, 2, v2
    v_add_u32 v28, s66, v28
    v_lshlrev_b32 v29, 4, v3
    v_add_u32 v29, s66, v29
    s_waitcnt lgkmcnt(0)
    v_add_f32 v64, v64, v80
    v_add_f32 v65, v65, v81
    v_add_f32 v66, v66, v82
    v_add_f32 v67, v67, v83
    v_add_f32 v68, v68, v84
    v_add_f32 v69, v69, v85
    v_add_f32 v70, v70, v86
    v_add_f32 v71, v71, v87
    v_add_f32 v72, v72, v88
    v_add_f32 v73, v73, v89
    v_add_f32 v74, v74, v90
    v_add_f32 v75, v75, v91
    v_add_f32 v76, v76, v92
    v_add_f32 v77, v77, v93
    v_add_f32 v78, v78, v94
    v_add_f32 v79, v79, v95
    v_add_f32 v26, v26, v27
    s_cmp_eq_u32 s3, 1
    s_cbranch_scc1 g_vepi
    ds_write_b32 v28, v26 offset:256
    s_waitcnt lgkmcnt(0)
    ds_read_b128 v[80:83], v29 offset:256
    ds_read_b128 v[84:87], v29 offset:288
    s_waitcnt lgkmcnt(0)
    s_mov_b64 exec, 1
    ds_add_u32 v9, v13 offset:44
    s_mov_b64 exec, -1
    v_fma_f32 v64, -v32, v80, v64
    v_fma_f32 v65, -v32, v81, v65
    v_fma_f32 v66, -v32, v82, v66
    v_fma_f32 v67, -v32, v83, v67
    v_fma_f32 v68, -v32, v84, v68
    v_fma_f32 v69, -v32, v85, v69
    v_fma_f32 v70, -v32, v86, v70
    v_fma_f32 v71, -v32, v87, v71
    v_mul_f32 v64, v33, v64
    v_mul_f32 v65, v33, v65
    v_mul_f32 v66, v33, v66
    v_mul_f32 v67, v33, v67
    v_mul_f32 v68, v33, v68
    v_mul_f32 v69, v33, v69
    v_mul_f32 v70, v33, v70
    v_mul_f32 v71, v33, v71
    v_cvt_pk_bf16_f32 v48, v64, v65
    v_cvt_pk_bf16_f32 v49, v66, v67
    v_cvt_pk_bf16_f32 v50, v68, v69
    v_cvt_pk_bf16_f32 v51, v70, v71
    s_lshl_b32 s66, s7, 1
    s_add_u32 s66, s66, s10
    s_lshl_b32 s66, s66, 11
    buffer_store_dwordx4 v[48:51], v1, s[44:47], s66 offen sc0 sc1
    s_branch g_kvst
g_vepi:
    ds_write_b32 v28, v32
    ds_write_b32 v28, v33 offset:128
    s_waitcnt lgkmcnt(0)
    ds_read_b128 v[80:83], v29 offset:0
    ds_read_b128 v[96:99], v29 offset:128
    ds_read_b128 v[84:87], v29 offset:32
    ds_read_b128 v[100:103], v29 offset:160
    ds_read_b128 v[88:91], v29 offset:64
    ds_read_b128 v[104:107], v29 offset:192
    ds_read_b128 v[92:95], v29 offset:96
    ds_read_b128 v[108:111], v29 offset:224
    v_lshlrev_b32 v14, 8, v3
    v_lshl_add_u32 v14, v2, 4, v14
    v_mov_b32 v15, 0x40000000
    v_cmp_gt_u32 vcc, 16, v2
    s_lshl_b32 s66, s7, 1
    s_add_u32 s66, s66, s10
    s_lshl_b32 s66, s66, 11
    s_add_u32 s66, s66, 1024
    v_cndmask_b32 v14, v15, v14, vcc
    s_waitcnt lgkmcnt(0)
    s_mov_b64 exec, 1
    ds_add_u32 v9, v13 offset:44
    s_mov_b64 exec, -1
    v_fma_f32 v64, -v80, v26, v64
    v_fma_f32 v65, -v81, v26, v65
    v_fma_f32 v66, -v82, v26, v66
    v_fma_f32 v67, -v83, v26, v67
    v_fma_f32 v68, -v84, v26, v68
    v_fma_f32 v69, -v85, v26, v69
    v_fma_f32 v70, -v86, v26, v70
    v_fma_f32 v71, -v87, v26, v71
    v_fma_f32 v72, -v88, v26, v72
    v_fma_f32 v73, -v89, v26, v73
    v_fma_f32 v74, -v90, v26, v74
    v_fma_f32 v75, -v91, v26, v75
    v_fma_f32 v76, -v92, v26, v76
    v_fma_f32 v77, -v93, v26, v77
    v_fma_f32 v78, -v94, v26, v78
    v_fma_f32 v79, -v95, v26, v79
    v_mul_f32 v64, v96, v64
    v_mul_f32 v65, v97, v65
    v_mul_f32 v66, v98, v66
    v_mul_f32 v67, v99, v67
    v_mul_f32 v68, v100, v68
    v_mul_f32 v69, v101, v69
    v_mul_f32 v70, v102, v70
    v_mul_f32 v71, v103, v71
    v_mul_f32 v72, v104, v72
    v_mul_f32 v73, v105, v73
    v_mul_f32 v74, v106, v74
    v_mul_f32 v75, v107, v75
    v_mul_f32 v76, v108, v76
    v_mul_f32 v77, v109, v77
    v_mul_f32 v78, v110, v78
    v_mul_f32 v79, v111, v79
    v_cvt_pk_bf16_f32 v48, v64, v65
    v_cvt_pk_bf16_f32 v49, v66, v67
    v_cvt_pk_bf16_f32 v50, v68, v69
    v_cvt_pk_bf16_f32 v51, v70, v71
    v_cvt_pk_bf16_f32 v52, v72, v73
    v_cvt_pk_bf16_f32 v53, v74, v75
    v_cvt_pk_bf16_f32 v54, v76, v77
    v_cvt_pk_bf16_f32 v55, v78, v79
    buffer_store_dwordx4 v[48:51], v14, s[44:47], s66 offen sc0 sc1
    buffer_store_dwordx4 v[52:55], v14, s[44:47], s66 offen offset:512 sc0 sc1
g_kvst:
    s_waitcnt vmcnt(0)
    v_mov_b32 v13, 1
    s_mov_b64 exec, 1
    ds_add_rtn_u32 v12, v9, v13 offset:24
    s_waitcnt lgkmcnt(0)
    s_mov_b64 exec, -1
    v_readfirstlane_b32 s66, v12
    s_nop 0
    s_cmp_eq_u32 s66, 1
    s_cbranch_scc0 g_kvb6
    s_lshl_b32 s66, s7, 1
    s_add_u32 s66, s66, s3
    s_lshl_b32 s66, s66, 2
    s_add_u32 s66, s66, 131072
    v_lshlrev_b32 v14, 8, v0
    v_mov_b32 v15, s15
    s_mov_b64 exec, 0xffff
    buffer_store_dword v15, v14, s[40:43], s66 offen sc0 sc1
    s_mov_b64 exec, -1
g_kvb6:
g_skipkv:
    s_cmp_eq_u32 s9, 3
    s_cbranch_scc0 g_noxr
    s_lshl_b32 s66, s7, 10
    s_lshl_b32 s67, s6, 7
    s_add_u32 s66, s66, s67
    s_add_u32 s67, s66, 393216
    v_lshlrev_b32 v10, 3, v0
g_xpoll:
    buffer_load_dwordx2 v[12:13], v10, s[40:43], s67 offen sc1
    s_waitcnt vmcnt(0)
    v_cmp_ne_u32 vcc, s15, v12
    s_nop 0
    s_and_b32 s66, vcc_lo, 0xff
    s_cmp_eq_u32 s66, 0
    s_cbranch_scc1 g_xok
    s_sleep 4
    s_branch g_xpoll
g_xok:
    v_cmp_ne_u32 vcc, s13, v13
    s_nop 0
    s_and_b32 s66, vcc_lo, 0xff
    s_cmp_eq_u32 s66, 0
    s_cselect_b32 s66, 2, 1
    v_mov_b32 v12, s66
    s_mov_b64 exec, 1
    ds_write_b32 v9, v12 offset:48
    s_mov_b64 exec, -1
g_noxr:
    s_mov_b32 s48, s28
    s_mov_b32 s49, s29
    s_mov_b32 s50, 1409024
    s_mov_b32 s51, 0x20000
    s_mov_b32 s52, s30
    s_mov_b32 s53, s31
    s_mov_b32 s54, 1409024
    s_mov_b32 s55, 0x20000
    s_lshl_b32 s10, s6, 2
    s_add_u32 s10, s10, s9
    s_cmp_eq_u32 s10, 27
    s_cselect_b32 s10, 31, s10
    s_cmp_eq_u32 s6, 7
    s_cbranch_scc0 g_nb7
    s_add_u32 s10, s9, 27
g_nb7:
    s_mov_b32 s69, 32768
    s_cmp_eq_u32 s9, 1
    s_cselect_b32 s69, 48128, s69
    s_cmp_eq_u32 s9, 2
    s_cselect_b32 s69, 132096, s69
    s_cmp_eq_u32 s9, 3
    s_cselect_b32 s69, 147456, s69
    s_mov_b32 s14, 0
    v_add_u32 v10, 0, v0
    v_mul_u32_u24 v11, 43691, v10
    v_lshrrev_b32 v11, 18, v11
    v_mul_u32_u24 v12, 6, v11
    v_sub_u32 v12, v10, v12
    v_mul_u32_u24 v11, 2752, v11
    v_lshl_add_u32 v4, v12, 4, v11
    v_add_u32 v10, 64, v0
    v_mul_u32_u24 v11, 43691, v10
    v_lshrrev_b32 v11, 18, v11
    v_mul_u32_u24 v12, 6, v11
    v_sub_u32 v12, v10, v12
    v_mul_u32_u24 v11, 2752, v11
    v_lshl_add_u32 v5, v12, 4, v11
    v_add_u32 v10, 0, v0
    v_mul_u32_u24 v11, 43691, v10
    v_lshrrev_b32 v11, 18, v11
    v_mul_u32_u24 v12, 6, v11
    v_sub_u32 v12, v10, v12
    v_add_u32 v11, 12, v11
    v_and_b32 v11, 15, v11
    v_mul_u32_u24 v11, 2752, v11
    v_lshl_add_u32 v6, v12, 4, v11
    v_add_u32 v10, 32, v0
    v_mul_u32_u24 v11, 43691, v10
    v_lshrrev_b32 v11, 18, v11
    v_mul_u32_u24 v12, 6, v11
    v_sub_u32 v12, v10, v12
    v_add_u32 v11, 12, v11
    v_and_b32 v11, 15, v11
    v_mul_u32_u24 v11, 2752, v11
    v_lshl_add_u32 v7, v12, 4, v11
    s_mul_i32 s68, s10, 96
    v_bfe_u32 v10, v0, 2, 2
    v_lshl_add_u32 v10, v3, 3, v10
    v_bfe_u32 v11, v0, 4, 1
    v_lshlrev_b32 v12, 2, v11
    v_add_u32 v13, v10, v12
    v_add_u32 v14, 4, v13
    v_and_b32 v14, 15, v14
    v_mul_u32_u24 v11, 1536, v11
    v_and_b32 v12, 3, v0
    v_lshl_add_u32 v11, v12, 3, v11
    v_add_u32 v11, s69, v11
    v_mul_u32_u24 v13, 96, v13
    v_mul_u32_u24 v14, 96, v14
    v_add_u32 v152, v11, v13
    v_add_u32 v153, v11, v14
    v_mul_u32_u24 v8, 1040, v2
    v_lshl_add_u32 v8, v3, 4, v8
    v_add_u32 v8, 65536, v8
    v_mov_b32 v16, 0
    v_mov_b32 v17, 0
    v_mov_b32 v18, 0
    v_mov_b32 v19, 0
    v_mov_b32 v20, 0
    v_mov_b32 v21, 0
    v_mov_b32 v22, 0
    v_mov_b32 v23, 0
    v_mov_b32 v24, 0
    v_mov_b32 v25, 0
    v_mov_b32 v26, 0
    v_mov_b32 v27, 0
    v_mov_b32 v28, 0
    v_mov_b32 v29, 0
    v_mov_b32 v30, 0
    v_mov_b32 v31, 0
    v_mov_b32 v32, 0
    v_mov_b32 v33, 0
    v_mov_b32 v34, 0
    v_mov_b32 v35, 0
    v_mov_b32 v36, 0
    v_mov_b32 v37, 0
    v_mov_b32 v38, 0
    v_mov_b32 v39, 0
    v_mov_b32 v40, 0
    v_mov_b32 v41, 0
    v_mov_b32 v42, 0
    v_mov_b32 v43, 0
    v_mov_b32 v44, 0
    v_mov_b32 v45, 0
    v_mov_b32 v46, 0
    v_mov_b32 v47, 0
    v_mov_b32 v48, 0
    v_mov_b32 v49, 0
    v_mov_b32 v50, 0
    v_mov_b32 v51, 0
    v_mov_b32 v52, 0
    v_mov_b32 v53, 0
    v_mov_b32 v54, 0
    v_mov_b32 v55, 0
    v_mov_b32 v56, 0
    v_mov_b32 v57, 0
    v_mov_b32 v58, 0
    v_mov_b32 v59, 0
    v_mov_b32 v60, 0
    v_mov_b32 v61, 0
    v_mov_b32 v62, 0
    v_mov_b32 v63, 0
    v_mov_b32 v64, 0
    v_mov_b32 v65, 0
    v_mov_b32 v66, 0
    v_mov_b32 v67, 0
    v_mov_b32 v68, 0
    v_mov_b32 v69, 0
    v_mov_b32 v70, 0
    v_mov_b32 v71, 0
    v_mov_b32 v72, 0
    v_mov_b32 v73, 0
    v_mov_b32 v74, 0
    v_mov_b32 v75, 0
    v_mov_b32 v76, 0
    v_mov_b32 v77, 0
    v_mov_b32 v78, 0
    v_mov_b32 v79, 0
    v_mov_b32 v80, 0
    v_mov_b32 v81, 0
    v_mov_b32 v82, 0
    v_mov_b32 v83, 0
    v_mov_b32 v84, 0
    v_mov_b32 v85, 0
    v_mov_b32 v86, 0
    v_mov_b32 v87, 0
    v_mov_b32 v88, 0
    v_mov_b32 v89, 0
    v_mov_b32 v90, 0
    v_mov_b32 v91, 0
    v_mov_b32 v92, 0
    v_mov_b32 v93, 0
    v_mov_b32 v94, 0
    v_mov_b32 v95, 0
    v_mov_b32 v96, 0
    v_mov_b32 v97, 0
    v_mov_b32 v98, 0
    v_mov_b32 v99, 0
    v_mov_b32 v100, 0
    v_mov_b32 v101, 0
    v_mov_b32 v102, 0
    v_mov_b32 v103, 0
    v_mov_b32 v104, 0
    v_mov_b32 v105, 0
    v_mov_b32 v106, 0
    v_mov_b32 v107, 0
    v_mov_b32 v108, 0
    v_mov_b32 v109, 0
    v_mov_b32 v110, 0
    v_mov_b32 v111, 0
g_wring:
    ds_read_b32 v10, v9 offset:32
    ds_read_b32 v11, v9 offset:44
    s_waitcnt lgkmcnt(0)
    v_readfirstlane_b32 s66, v10
    v_readfirstlane_b32 s67, v11
    s_nop 0
    s_cmp_ge_u32 s9, 2
    s_cselect_b32 s66, 8, s66
    s_cmp_ge_u32 s66, 8
    s_cselect_b32 s66, s67, 0
    s_cmp_ge_u32 s66, 4
    s_cbranch_scc1 g_ringok
    s_sleep 1
    s_branch g_wring
g_ringok:
    s_setprio 0
    s_cmp_gt_u32 s10, 28
    s_cbranch_scc1 g_idle
    s_add_u32 m0, s69, 0
    s_nop 0
    buffer_load_dwordx4 v4, s[48:51], s68 offen lds
    s_add_u32 m0, s69, 2048
    s_nop 0
    buffer_load_dwordx4 v7, s[52:55], s68 offen lds
    s_add_u32 m0, s69, 1536
    s_mov_b64 exec, 0xffffffff
    buffer_load_dwordx4 v6, s[52:55], s68 offen lds
    s_add_u32 m0, s69, 1024
    s_nop 0
    buffer_load_dwordx4 v5, s[48:51], s68 offen lds
    s_mov_b64 exec, -1
    s_add_u32 s68, s68, 44032
    s_add_u32 m0, s69, 3072
    s_nop 0
    buffer_load_dwordx4 v4, s[48:51], s68 offen lds
    s_add_u32 m0, s69, 5120
    s_nop 0
    buffer_load_dwordx4 v7, s[52:55], s68 offen lds
    s_add_u32 m0, s69, 4608
    s_mov_b64 exec, 0xffffffff
    buffer_load_dwordx4 v6, s[52:55], s68 offen lds
    s_add_u32 m0, s69, 4096
    s_nop 0
    buffer_load_dwordx4 v5, s[48:51], s68 offen lds
    s_mov_b64 exec, -1
    s_add_u32 s68, s68, 44032
    s_add_u32 m0, s69, 6144
    s_nop 0
    buffer_load_dwordx4 v4, s[48:51], s68 offen lds
    s_add_u32 m0, s69, 8192
    s_nop 0
    buffer_load_dwordx4 v7, s[52:55], s68 offen lds
    s_add_u32 m0, s69, 7680
    s_mov_b64 exec, 0xffffffff
    buffer_load_dwordx4 v6, s[52:55], s68 offen lds
    s_add_u32 m0, s69, 7168
    s_nop 0
    buffer_load_dwordx4 v5, s[48:51], s68 offen lds
    s_mov_b64 exec, -1
    s_add_u32 s68, s68, 44032
    s_add_u32 m0, s69, 9216
    s_nop 0
    buffer_load_dwordx4 v4, s[48:51], s68 offen lds
    s_add_u32 m0, s69, 11264
    s_nop 0
    buffer_load_dwordx4 v7, s[52:55], s68 offen lds
    s_add_u32 m0, s69, 10752
    s_mov_b64 exec, 0xffffffff
    buffer_load_dwordx4 v6, s[52:55], s68 offen lds
    s_add_u32 m0, s69, 10240
    s_nop 0
    buffer_load_dwordx4 v5, s[48:51], s68 offen lds
    s_mov_b64 exec, -1
    s_add_u32 s68, s68, 44032
    s_cmp_eq_u32 s9, 1
    s_cbranch_scc0 g_npf4
    v_lshlrev_b32 v10, 7, v0
    v_add_u32 v10, g_hepi - k_pcref, v10
    s_mov_b32 s66, g_red - k_pcref - 4
    v_min_i32 v10, s66, v10
    v_mov_b32 v13, s77
    v_ashrrev_i32 v11, 31, v10
    v_add_co_u32 v12, vcc, s76, v10
    s_nop 1
    v_addc_co_u32 v13, vcc, v11, v13, vcc
    global_load_dword v157, v[12:13], off
g_npf4:
g_wxn:
    ds_read_b32 v10, v9 offset:40
    ds_read_b32 v11, v9 offset:44
    s_waitcnt lgkmcnt(0)
    v_readfirstlane_b32 s66, v10
    v_readfirstlane_b32 s67, v11
    s_nop 0
    s_cmp_ge_u32 s66, 8
    s_cselect_b32 s66, s67, 0
    s_cmp_ge_u32 s66, 4
    s_cbranch_scc1 g_gateup
    s_sleep 1
    s_branch g_wxn
g_gateup:
    s_setprio 0
    s_waitcnt vmcnt(12)
g_gu_start:
    ds_read_b64_tr_b16 v[112:113], v152 offset:0
    ds_read_b64_tr_b16 v[114:115], v153 offset:0
    ds_read_b64_tr_b16 v[116:117], v152 offset:32
    ds_read_b64_tr_b16 v[118:119], v153 offset:32
    ds_read_b64_tr_b16 v[120:121], v152 offset:64
    ds_read_b64_tr_b16 v[122:123], v153 offset:64
    ds_read_b128 v[136:139], v8 offset:0
    ds_read_b128 v[140:143], v8 offset:33280
    s_mov_b32 s12, 8
g_loop:
    s_waitcnt vmcnt(8)
    ds_read_b64_tr_b16 v[124:125], v152 offset:3072
    ds_read_b64_tr_b16 v[126:127], v153 offset:3072
    ds_read_b64_tr_b16 v[128:129], v152 offset:3104
    ds_read_b64_tr_b16 v[130:131], v153 offset:3104
    ds_read_b64_tr_b16 v[132:133], v152 offset:3136
    ds_read_b64_tr_b16 v[134:135], v153 offset:3136
    ds_read_b128 v[144:147], v8 offset:32
    ds_read_b128 v[148:151], v8 offset:33312
    s_waitcnt lgkmcnt(8)
    s_add_u32 m0, s69, 0
    s_nop 0
    buffer_load_dwordx4 v4, s[48:51], s68 offen lds
    v_mfma_f32_32x32x16_bf16 v[16:31], v[112:115], v[136:139], v[16:31]
    v_mfma_f32_32x32x16_bf16 v[32:47], v[112:115], v[140:143], v[32:47]
    s_add_u32 m0, s69, 2048
    s_nop 0
    buffer_load_dwordx4 v7, s[52:55], s68 offen lds
    v_mfma_f32_32x32x16_bf16 v[48:63], v[116:119], v[136:139], v[48:63]
    v_mfma_f32_32x32x16_bf16 v[64:79], v[116:119], v[140:143], v[64:79]
    s_add_u32 m0, s69, 1536
    s_mov_b64 exec, 0xffffffff
    buffer_load_dwordx4 v6, s[52:55], s68 offen lds
    s_add_u32 m0, s69, 1024
    s_nop 0
    buffer_load_dwordx4 v5, s[48:51], s68 offen lds
    s_mov_b64 exec, -1
    s_add_u32 s68, s68, 44032
    v_mfma_f32_32x32x16_bf16 v[80:95], v[120:123], v[136:139], v[80:95]
    v_mfma_f32_32x32x16_bf16 v[96:111], v[120:123], v[140:143], v[96:111]
    s_waitcnt vmcnt(8)
    ds_read_b64_tr_b16 v[112:113], v152 offset:6144
    ds_read_b64_tr_b16 v[114:115], v153 offset:6144
    ds_read_b64_tr_b16 v[116:117], v152 offset:6176
    ds_read_b64_tr_b16 v[118:119], v153 offset:6176
    ds_read_b64_tr_b16 v[120:121], v152 offset:6208
    ds_read_b64_tr_b16 v[122:123], v153 offset:6208
    ds_read_b128 v[136:139], v8 offset:64
    ds_read_b128 v[140:143], v8 offset:33344
    s_waitcnt lgkmcnt(8)
    s_add_u32 m0, s69, 3072
    s_nop 0
    buffer_load_dwordx4 v4, s[48:51], s68 offen lds
    v_mfma_f32_32x32x16_bf16 v[16:31], v[124:127], v[144:147], v[16:31]
    v_mfma_f32_32x32x16_bf16 v[32:47], v[124:127], v[148:151], v[32:47]
    s_add_u32 m0, s69, 5120
    s_nop 0
    buffer_load_dwordx4 v7, s[52:55], s68 offen lds
    v_mfma_f32_32x32x16_bf16 v[48:63], v[128:131], v[144:147], v[48:63]
    v_mfma_f32_32x32x16_bf16 v[64:79], v[128:131], v[148:151], v[64:79]
    s_add_u32 m0, s69, 4608
    s_mov_b64 exec, 0xffffffff
    buffer_load_dwordx4 v6, s[52:55], s68 offen lds
    s_add_u32 m0, s69, 4096
    s_nop 0
    buffer_load_dwordx4 v5, s[48:51], s68 offen lds
    s_mov_b64 exec, -1
    s_add_u32 s68, s68, 44032
    v_mfma_f32_32x32x16_bf16 v[80:95], v[132:135], v[144:147], v[80:95]
    v_mfma_f32_32x32x16_bf16 v[96:111], v[132:135], v[148:151], v[96:111]
    s_waitcnt vmcnt(8)
    ds_read_b64_tr_b16 v[124:125], v152 offset:9216
    ds_read_b64_tr_b16 v[126:127], v153 offset:9216
    ds_read_b64_tr_b16 v[128:129], v152 offset:9248
    ds_read_b64_tr_b16 v[130:131], v153 offset:9248
    ds_read_b64_tr_b16 v[132:133], v152 offset:9280
    ds_read_b64_tr_b16 v[134:135], v153 offset:9280
    ds_read_b128 v[144:147], v8 offset:96
    ds_read_b128 v[148:151], v8 offset:33376
    s_waitcnt lgkmcnt(8)
    s_add_u32 m0, s69, 6144
    s_nop 0
    buffer_load_dwordx4 v4, s[48:51], s68 offen lds
    v_mfma_f32_32x32x16_bf16 v[16:31], v[112:115], v[136:139], v[16:31]
    v_mfma_f32_32x32x16_bf16 v[32:47], v[112:115], v[140:143], v[32:47]
    s_add_u32 m0, s69, 8192
    s_nop 0
    buffer_load_dwordx4 v7, s[52:55], s68 offen lds
    v_mfma_f32_32x32x16_bf16 v[48:63], v[116:119], v[136:139], v[48:63]
    v_mfma_f32_32x32x16_bf16 v[64:79], v[116:119], v[140:143], v[64:79]
    s_add_u32 m0, s69, 7680
    s_mov_b64 exec, 0xffffffff
    buffer_load_dwordx4 v6, s[52:55], s68 offen lds
    s_add_u32 m0, s69, 7168
    s_nop 0
    buffer_load_dwordx4 v5, s[48:51], s68 offen lds
    s_mov_b64 exec, -1
    s_add_u32 s68, s68, 44032
    v_mfma_f32_32x32x16_bf16 v[80:95], v[120:123], v[136:139], v[80:95]
    v_mfma_f32_32x32x16_bf16 v[96:111], v[120:123], v[140:143], v[96:111]
    s_waitcnt vmcnt(8)
    ds_read_b64_tr_b16 v[112:113], v152 offset:0
    ds_read_b64_tr_b16 v[114:115], v153 offset:0
    ds_read_b64_tr_b16 v[116:117], v152 offset:32
    ds_read_b64_tr_b16 v[118:119], v153 offset:32
    ds_read_b64_tr_b16 v[120:121], v152 offset:64
    ds_read_b64_tr_b16 v[122:123], v153 offset:64
    ds_read_b128 v[136:139], v8 offset:128
    ds_read_b128 v[140:143], v8 offset:33408
    s_waitcnt lgkmcnt(8)
    s_add_u32 m0, s69, 9216
    s_nop 0
    buffer_load_dwordx4 v4, s[48:51], s68 offen lds
    v_mfma_f32_32x32x16_bf16 v[16:31], v[124:127], v[144:147], v[16:31]
    v_mfma_f32_32x32x16_bf16 v[32:47], v[124:127], v[148:151], v[32:47]
    s_add_u32 m0, s69, 11264
    s_nop 0
    buffer_load_dwordx4 v7, s[52:55], s68 offen lds
    v_mfma_f32_32x32x16_bf16 v[48:63], v[128:131], v[144:147], v[48:63]
    v_mfma_f32_32x32x16_bf16 v[64:79], v[128:131], v[148:151], v[64:79]
    s_add_u32 m0, s69, 10752
    s_mov_b64 exec, 0xffffffff
    buffer_load_dwordx4 v6, s[52:55], s68 offen lds
    s_add_u32 m0, s69, 10240
    s_nop 0
    buffer_load_dwordx4 v5, s[48:51], s68 offen lds
    s_mov_b64 exec, -1
    s_add_u32 s68, s68, 44032
    v_mfma_f32_32x32x16_bf16 v[80:95], v[132:135], v[144:147], v[80:95]
    v_mfma_f32_32x32x16_bf16 v[96:111], v[132:135], v[148:151], v[96:111]
    v_add_u32 v8, 128, v8
    s_sub_u32 s12, s12, 1
    s_cmp_lg_u32 s12, 0
    s_cbranch_scc1 g_loop
g_hepi:
    s_setprio 3
    s_waitcnt vmcnt(0) lgkmcnt(0)
    s_nop 7
    s_nop 3
rm_h:
    ds_read_b32 v10, v9 offset:48
    s_waitcnt lgkmcnt(0)
    v_readfirstlane_b32 s13, v10
    s_nop 0
    s_cmp_eq_u32 s13, 0
    s_cbranch_scc1 rm_h
    s_mov_b32 s66, 0xbfb8aa3b
    s_mov_b32 s67, s66
    s_mov_b32 s72, 1.0
    s_mov_b32 s73, 1.0
    s_mul_i32 s70, s7, 172
    s_mul_i32 s71, s10, 3
    s_add_u32 s70, s70, s71
    s_lshl_b32 s70, s70, 10
    s_add_u32 s70, s70, 1048576
    v_pk_mul_f32 v[112:113], v[16:17], s[66:67]
    v_pk_mul_f32 v[114:115], v[18:19], s[66:67]
    v_pk_mul_f32 v[116:117], v[20:21], s[66:67]
    v_pk_mul_f32 v[118:119], v[22:23], s[66:67]
    v_exp_f32 v112, v112
    v_exp_f32 v113, v113
    v_exp_f32 v114, v114
    v_exp_f32 v115, v115
    v_exp_f32 v116, v116
    v_exp_f32 v117, v117
    v_exp_f32 v118, v118
    v_exp_f32 v119, v119
    v_pk_mul_f32 v[16:17], v[16:17], v[24:25]
    v_pk_mul_f32 v[18:19], v[18:19], v[26:27]
    v_pk_mul_f32 v[20:21], v[20:21], v[28:29]
    v_pk_mul_f32 v[22:23], v[22:23], v[30:31]
    v_pk_add_f32 v[112:113], v[112:113], s[72:73]
    v_pk_add_f32 v[114:115], v[114:115], s[72:73]
    v_pk_add_f32 v[116:117], v[116:117], s[72:73]
    v_pk_add_f32 v[118:119], v[118:119], s[72:73]
    v_rcp_f32 v112, v112
    v_rcp_f32 v113, v113
    v_rcp_f32 v114, v114
    v_rcp_f32 v115, v115
    v_rcp_f32 v116, v116
    v_rcp_f32 v117, v117
    v_rcp_f32 v118, v118
    v_rcp_f32 v119, v119
    s_nop 0
    v_pk_mul_f32 v[16:17], v[16:17], v[112:113]
    v_pk_mul_f32 v[18:19], v[18:19], v[114:115]
    v_pk_mul_f32 v[20:21], v[20:21], v[116:117]
    v_pk_mul_f32 v[22:23], v[22:23], v[118:119]
    v_cvt_pk_bf16_f32 v120, v16, v17
    v_cvt_pk_bf16_f32 v121, v18, v19
    v_cvt_pk_bf16_f32 v122, v20, v21
    v_cvt_pk_bf16_f32 v123, v22, v23
    s_add_u32 s71, s70, 0
    buffer_store_dwordx4 v[120:123], v1, s[40:43], s71 offen sc0 sc1
    v_pk_mul_f32 v[112:113], v[32:33], s[66:67]
    v_pk_mul_f32 v[114:115], v[34:35], s[66:67]
    v_pk_mul_f32 v[116:117], v[36:37], s[66:67]
    v_pk_mul_f32 v[118:119], v[38:39], s[66:67]
    v_exp_f32 v112, v112
    v_exp_f32 v113, v113
    v_exp_f32 v114, v114
    v_exp_f32 v115, v115
    v_exp_f32 v116, v116
    v_exp_f32 v117, v117
    v_exp_f32 v118, v118
    v_exp_f32 v119, v119
    v_pk_mul_f32 v[32:33], v[32:33], v[40:41]
    v_pk_mul_f32 v[34:35], v[34:35], v[42:43]
    v_pk_mul_f32 v[36:37], v[36:37], v[44:45]
    v_pk_mul_f32 v[38:39], v[38:39], v[46:47]
    v_pk_add_f32 v[112:113], v[112:113], s[72:73]
    v_pk_add_f32 v[114:115], v[114:115], s[72:73]
    v_pk_add_f32 v[116:117], v[116:117], s[72:73]
    v_pk_add_f32 v[118:119], v[118:119], s[72:73]
    v_rcp_f32 v112, v112
    v_rcp_f32 v113, v113
    v_rcp_f32 v114, v114
    v_rcp_f32 v115, v115
    v_rcp_f32 v116, v116
    v_rcp_f32 v117, v117
    v_rcp_f32 v118, v118
    v_rcp_f32 v119, v119
    s_nop 0
    v_pk_mul_f32 v[32:33], v[32:33], v[112:113]
    v_pk_mul_f32 v[34:35], v[34:35], v[114:115]
    v_pk_mul_f32 v[36:37], v[36:37], v[116:117]
    v_pk_mul_f32 v[38:39], v[38:39], v[118:119]
    v_cvt_pk_bf16_f32 v124, v32, v33
    v_cvt_pk_bf16_f32 v125, v34, v35
    v_cvt_pk_bf16_f32 v126, v36, v37
    v_cvt_pk_bf16_f32 v127, v38, v39
    s_add_u32 s71, s70, 88064
    buffer_store_dwordx4 v[124:127], v1, s[40:43], s71 offen sc0 sc1
    v_pk_mul_f32 v[112:113], v[48:49], s[66:67]
    v_pk_mul_f32 v[114:115], v[50:51], s[66:67]
    v_pk_mul_f32 v[116:117], v[52:53], s[66:67]
    v_pk_mul_f32 v[118:119], v[54:55], s[66:67]
    v_exp_f32 v112, v112
    v_exp_f32 v113, v113
    v_exp_f32 v114, v114
    v_exp_f32 v115, v115
    v_exp_f32 v116, v116
    v_exp_f32 v117, v117
    v_exp_f32 v118, v118
    v_exp_f32 v119, v119
    v_pk_mul_f32 v[48:49], v[48:49], v[56:57]
    v_pk_mul_f32 v[50:51], v[50:51], v[58:59]
    v_pk_mul_f32 v[52:53], v[52:53], v[60:61]
    v_pk_mul_f32 v[54:55], v[54:55], v[62:63]
    v_pk_add_f32 v[112:113], v[112:113], s[72:73]
    v_pk_add_f32 v[114:115], v[114:115], s[72:73]
    v_pk_add_f32 v[116:117], v[116:117], s[72:73]
    v_pk_add_f32 v[118:119], v[118:119], s[72:73]
    v_rcp_f32 v112, v112
    v_rcp_f32 v113, v113
    v_rcp_f32 v114, v114
    v_rcp_f32 v115, v115
    v_rcp_f32 v116, v116
    v_rcp_f32 v117, v117
    v_rcp_f32 v118, v118
    v_rcp_f32 v119, v119
    s_nop 0
    v_pk_mul_f32 v[48:49], v[48:49], v[112:113]
    v_pk_mul_f32 v[50:51], v[50:51], v[114:115]
    v_pk_mul_f32 v[52:53], v[52:53], v[116:117]
    v_pk_mul_f32 v[54:55], v[54:55], v[118:119]
    v_cvt_pk_bf16_f32 v120, v48, v49
    v_cvt_pk_bf16_f32 v121, v50, v51
    v_cvt_pk_bf16_f32 v122, v52, v53
    v_cvt_pk_bf16_f32 v123, v54, v55
    s_add_u32 s71, s70, 1024
    buffer_store_dwordx4 v[120:123], v1, s[40:43], s71 offen sc0 sc1
    v_pk_mul_f32 v[112:113], v[64:65], s[66:67]
    v_pk_mul_f32 v[114:115], v[66:67], s[66:67]
    v_pk_mul_f32 v[116:117], v[68:69], s[66:67]
    v_pk_mul_f32 v[118:119], v[70:71], s[66:67]
    v_exp_f32 v112, v112
    v_exp_f32 v113, v113
    v_exp_f32 v114, v114
    v_exp_f32 v115, v115
    v_exp_f32 v116, v116
    v_exp_f32 v117, v117
    v_exp_f32 v118, v118
    v_exp_f32 v119, v119
    v_pk_mul_f32 v[64:65], v[64:65], v[72:73]
    v_pk_mul_f32 v[66:67], v[66:67], v[74:75]
    v_pk_mul_f32 v[68:69], v[68:69], v[76:77]
    v_pk_mul_f32 v[70:71], v[70:71], v[78:79]
    v_pk_add_f32 v[112:113], v[112:113], s[72:73]
    v_pk_add_f32 v[114:115], v[114:115], s[72:73]
    v_pk_add_f32 v[116:117], v[116:117], s[72:73]
    v_pk_add_f32 v[118:119], v[118:119], s[72:73]
    v_rcp_f32 v112, v112
    v_rcp_f32 v113, v113
    v_rcp_f32 v114, v114
    v_rcp_f32 v115, v115
    v_rcp_f32 v116, v116
    v_rcp_f32 v117, v117
    v_rcp_f32 v118, v118
    v_rcp_f32 v119, v119
    s_nop 0
    v_pk_mul_f32 v[64:65], v[64:65], v[112:113]
    v_pk_mul_f32 v[66:67], v[66:67], v[114:115]
    v_pk_mul_f32 v[68:69], v[68:69], v[116:117]
    v_pk_mul_f32 v[70:71], v[70:71], v[118:119]
    v_cvt_pk_bf16_f32 v124, v64, v65
    v_cvt_pk_bf16_f32 v125, v66, v67
    v_cvt_pk_bf16_f32 v126, v68, v69
    v_cvt_pk_bf16_f32 v127, v70, v71
    s_add_u32 s71, s70, 89088
    buffer_store_dwordx4 v[124:127], v1, s[40:43], s71 offen sc0 sc1
    s_cmp_eq_u32 s10, 28
    s_cbranch_scc1 g_hdone
    v_pk_mul_f32 v[112:113], v[80:81], s[66:67]
    v_pk_mul_f32 v[114:115], v[82:83], s[66:67]
    v_pk_mul_f32 v[116:117], v[84:85], s[66:67]
    v_pk_mul_f32 v[118:119], v[86:87], s[66:67]
    v_exp_f32 v112, v112
    v_exp_f32 v113, v113
    v_exp_f32 v114, v114
    v_exp_f32 v115, v115
    v_exp_f32 v116, v116
    v_exp_f32 v117, v117
    v_exp_f32 v118, v118
    v_exp_f32 v119, v119
    v_pk_mul_f32 v[80:81], v[80:81], v[88:89]
    v_pk_mul_f32 v[82:83], v[82:83], v[90:91]
    v_pk_mul_f32 v[84:85], v[84:85], v[92:93]
    v_pk_mul_f32 v[86:87], v[86:87], v[94:95]
    v_pk_add_f32 v[112:113], v[112:113], s[72:73]
    v_pk_add_f32 v[114:115], v[114:115], s[72:73]
    v_pk_add_f32 v[116:117], v[116:117], s[72:73]
    v_pk_add_f32 v[118:119], v[118:119], s[72:73]
    v_rcp_f32 v112, v112
    v_rcp_f32 v113, v113
    v_rcp_f32 v114, v114
    v_rcp_f32 v115, v115
    v_rcp_f32 v116, v116
    v_rcp_f32 v117, v117
    v_rcp_f32 v118, v118
    v_rcp_f32 v119, v119
    s_nop 0
    v_pk_mul_f32 v[80:81], v[80:81], v[112:113]
    v_pk_mul_f32 v[82:83], v[82:83], v[114:115]
    v_pk_mul_f32 v[84:85], v[84:85], v[116:117]
    v_pk_mul_f32 v[86:87], v[86:87], v[118:119]
    v_cvt_pk_bf16_f32 v120, v80, v81
    v_cvt_pk_bf16_f32 v121, v82, v83
    v_cvt_pk_bf16_f32 v122, v84, v85
    v_cvt_pk_bf16_f32 v123, v86, v87
    s_add_u32 s71, s70, 2048
    buffer_store_dwordx4 v[120:123], v1, s[40:43], s71 offen sc0 sc1
    v_pk_mul_f32 v[112:113], v[96:97], s[66:67]
    v_pk_mul_f32 v[114:115], v[98:99], s[66:67]
    v_pk_mul_f32 v[116:117], v[100:101], s[66:67]
    v_pk_mul_f32 v[118:119], v[102:103], s[66:67]
    v_exp_f32 v112, v112
    v_exp_f32 v113, v113
    v_exp_f32 v114, v114
    v_exp_f32 v115, v115
    v_exp_f32 v116, v116
    v_exp_f32 v117, v117
    v_exp_f32 v118, v118
    v_exp_f32 v119, v119
    v_pk_mul_f32 v[96:97], v[96:97], v[104:105]
    v_pk_mul_f32 v[98:99], v[98:99], v[106:107]
    v_pk_mul_f32 v[100:101], v[100:101], v[108:109]
    v_pk_mul_f32 v[102:103], v[102:103], v[110:111]
    v_pk_add_f32 v[112:113], v[112:113], s[72:73]
    v_pk_add_f32 v[114:115], v[114:115], s[72:73]
    v_pk_add_f32 v[116:117], v[116:117], s[72:73]
    v_pk_add_f32 v[118:119], v[118:119], s[72:73]
    v_rcp_f32 v112, v112
    v_rcp_f32 v113, v113
    v_rcp_f32 v114, v114
    v_rcp_f32 v115, v115
    v_rcp_f32 v116, v116
    v_rcp_f32 v117, v117
    v_rcp_f32 v118, v118
    v_rcp_f32 v119, v119
    s_nop 0
    v_pk_mul_f32 v[96:97], v[96:97], v[112:113]
    v_pk_mul_f32 v[98:99], v[98:99], v[114:115]
    v_pk_mul_f32 v[100:101], v[100:101], v[116:117]
    v_pk_mul_f32 v[102:103], v[102:103], v[118:119]
    v_cvt_pk_bf16_f32 v124, v96, v97
    v_cvt_pk_bf16_f32 v125, v98, v99
    v_cvt_pk_bf16_f32 v126, v100, v101
    v_cvt_pk_bf16_f32 v127, v102, v103
    s_add_u32 s71, s70, 90112
    buffer_store_dwordx4 v[124:127], v1, s[40:43], s71 offen sc0 sc1
g_hdone:
    s_setprio 0
    s_lshl_b32 s70, s7, 10
    s_lshl_b32 s71, s6, 2
    s_add_u32 s70, s70, s71
    s_add_u32 s70, s70, 262144
    v_lshlrev_b32 v10, 7, v0
    v_mov_b32 v11, s15
    v_mov_b32 v12, 1
    s_cmp_eq_u32 s6, 7
    s_cselect_b32 s71, 1, 3
    s_cmp_eq_u32 s6, 6
    s_cselect_b32 s71, 2, s71
    s_waitcnt vmcnt(0)
    s_mov_b64 exec, 1
    ds_add_rtn_u32 v13, v9, v12 offset:28
    s_waitcnt lgkmcnt(0)
    v_readfirstlane_b32 s66, v13
    s_nop 0
    s_cmp_eq_u32 s66, s71
    s_cbranch_scc0 g_hnf
    s_mov_b64 exec, 0xff
    buffer_store_dword v11, v10, s[40:43], s70 offen sc0 sc1
g_hnf:
    s_mov_b64 exec, -1
    s_branch g_after_h
g_idle:
g_after_h:
    v_mov_b32 v160, 0
    s_cmp_eq_u32 s9, 3
    s_cbranch_scc0 g_noep
    v_mov_b32 v10, 0
    v_mov_b32 v160, 1
    s_mov_b64 exec, 1
    buffer_atomic_add v160, v10, s[60:63], 0 offen sc0 sc1
    s_mov_b64 exec, -1
g_noep:
    s_waitcnt lgkmcnt(0)
    s_add_u32 s14, s14, 4
    s_mov_b64 exec, 1
    v_mov_b32 v10, 1
    ds_add_u32 v9, v10 offset:12
    s_mov_b64 exec, -1
gs_x:
    ds_read_b32 v10, v9 offset:12
    s_waitcnt lgkmcnt(0)
    v_readfirstlane_b32 s66, v10
    s_nop 0
    s_cmp_ge_u32 s66, s14
    s_cbranch_scc1 gs_x_ok
    s_sleep 1
    s_branch gs_x
gs_x_ok:
    s_mov_b32 s48, s24
    s_mov_b32 s49, s25
    s_mov_b32 s50, 524288
    s_mov_b32 s51, 0x20000
    v_lshrrev_b32 v4, 3, v0
    v_bfe_u32 v10, v4, 1, 1
    v_lshlrev_b32 v10, 2, v10
    v_and_b32 v11, 7, v0
    v_xor_b32 v10, v10, v11
    v_lshlrev_b32 v10, 4, v10
    v_lshl_add_u32 v4, v4, 10, v10
    v_bfe_u32 v7, v0, 2, 2
    v_lshl_add_u32 v7, v3, 2, v7
    v_lshlrev_b32 v7, 7, v7
    v_bfe_u32 v10, v0, 4, 1
    v_lshlrev_b32 v10, 1, v10
    v_bfe_u32 v11, v0, 1, 1
    v_add_u32 v10, v10, v11
    v_bfe_u32 v11, v0, 3, 1
    v_lshlrev_b32 v11, 2, v11
    v_xor_b32 v10, v10, v11
    v_lshl_add_u32 v7, v10, 4, v7
    v_and_b32 v10, 1, v0
    v_lshl_add_u32 v7, v10, 3, v7
    s_lshl_b32 s66, s9, 17
    s_lshl_b32 s67, s6, 7
    s_add_u32 s66, s66, s67
    s_lshl_b32 s67, s9, 14
    s_add_u32 s67, s67, 65536
    s_mov_b32 m0, s67
    s_add_u32 s67, s67, 1024
    buffer_load_dwordx4 v4, s[48:51], s66 offen lds
    s_add_u32 s66, s66, 8192
    s_mov_b32 m0, s67
    s_add_u32 s67, s67, 1024
    buffer_load_dwordx4 v4, s[48:51], s66 offen lds
    s_add_u32 s66, s66, 8192
    s_mov_b32 m0, s67
    s_add_u32 s67, s67, 1024
    buffer_load_dwordx4 v4, s[48:51], s66 offen lds
    s_add_u32 s66, s66, 8192
    s_mov_b32 m0, s67
    s_add_u32 s67, s67, 1024
    buffer_load_dwordx4 v4, s[48:51], s66 offen lds
    s_add_u32 s66, s66, 8192
    s_mov_b32 m0, s67
    s_add_u32 s67, s67, 1024
    buffer_load_dwordx4 v4, s[48:51], s66 offen lds
    s_add_u32 s66, s66, 8192
    s_mov_b32 m0, s67
    s_add_u32 s67, s67, 1024
    buffer_load_dwordx4 v4, s[48:51], s66 offen lds
    s_add_u32 s66, s66, 8192
    s_mov_b32 m0, s67
    s_add_u32 s67, s67, 1024
    buffer_load_dwordx4 v4, s[48:51], s66 offen lds
    s_add_u32 s66, s66, 8192
    s_mov_b32 m0, s67
    s_add_u32 s67, s67, 1024
    buffer_load_dwordx4 v4, s[48:51], s66 offen lds
    s_add_u32 s66, s66, 8192
    s_mov_b32 m0, s67
    s_add_u32 s67, s67, 1024
    buffer_load_dwordx4 v4, s[48:51], s66 offen lds
    s_add_u32 s66, s66, 8192
    s_mov_b32 m0, s67
    s_add_u32 s67, s67, 1024
    buffer_load_dwordx4 v4, s[48:51], s66 offen lds
    s_add_u32 s66, s66, 8192
    s_mov_b32 m0, s67
    s_add_u32 s67, s67, 1024
    buffer_load_dwordx4 v4, s[48:51], s66 offen lds
    s_add_u32 s66, s66, 8192
    s_mov_b32 m0, s67
    s_add_u32 s67, s67, 1024
    buffer_load_dwordx4 v4, s[48:51], s66 offen lds
    s_add_u32 s66, s66, 8192
    s_mov_b32 m0, s67
    s_add_u32 s67, s67, 1024
    buffer_load_dwordx4 v4, s[48:51], s66 offen lds
    s_add_u32 s66, s66, 8192
    s_mov_b32 m0, s67
    s_add_u32 s67, s67, 1024
    buffer_load_dwordx4 v4, s[48:51], s66 offen lds
    s_add_u32 s66, s66, 8192
    s_mov_b32 m0, s67
    s_add_u32 s67, s67, 1024
    buffer_load_dwordx4 v4, s[48:51], s66 offen lds
    s_add_u32 s66, s66, 8192
    s_mov_b32 m0, s67
    s_add_u32 s67, s67, 1024
    buffer_load_dwordx4 v4, s[48:51], s66 offen lds
    s_add_u32 s66, s66, 8192
    s_mov_b32 s48, s32
    s_mov_b32 s49, s33
    s_mov_b32 s50, 1409024
    s_mov_b32 s51, 0x20000
    s_mul_i32 s66, s7, 176128
    s_add_u32 s66, s66, 1048576
    s_add_u32 s52, s38, s66
    s_addc_u32 s53, s39, 0
    s_mov_b32 s54, 88064
    s_mov_b32 s55, 0x20000
    s_add_u32 s56, s52, 88064
    s_addc_u32 s57, s53, 0
    s_mov_b32 s58, 88064
    s_mov_b32 s59, 0x20000
    s_mul_i32 s68, s9, 360448
    s_lshl_b32 s66, s6, 7
    s_add_u32 s68, s68, s66
    v_add_u32 v5, s69, v7
    v_xor_b32 v6, 64, v5
    s_lshl_b32 s70, s7, 10
    s_lshl_b32 s66, s6, 7
    s_add_u32 s70, s70, s66
    s_add_u32 s70, s70, 262144
    v_lshlrev_b32 v10, 2, v0
    s_cmp_eq_u32 s9, 0
    s_cbranch_scc0 g_nohp
pf_h:
    buffer_load_dword v11, v10, s[40:43], s70 offen sc1
    s_waitcnt vmcnt(0)
    v_cmp_ne_u32 vcc, s15, v11
    s_nop 0
    s_and_b32 s66, vcc_lo, 0xff
    s_cmp_eq_u32 s66, 0
    s_cbranch_scc1 pf_h_ok
    s_sleep 8
    s_branch pf_h
pf_h_ok:
g_nohp:
    s_waitcnt vmcnt(0)
    s_waitcnt lgkmcnt(0)
    s_add_u32 s14, s14, 4
    s_mov_b64 exec, 1
    v_mov_b32 v12, 1
    ds_add_u32 v9, v12 offset:12
    s_mov_b64 exec, -1
gs_h:
    ds_read_b32 v12, v9 offset:12
    s_waitcnt lgkmcnt(0)
    v_readfirstlane_b32 s66, v12
    s_nop 0
    s_cmp_ge_u32 s66, s14
    s_cbranch_scc1 gs_h_ok
    s_sleep 1
    s_branch gs_h
gs_h_ok:
    v_readfirstlane_b32 s66, v160
    s_nop 0
    s_cmp_eq_u32 s66, 255
    s_cbranch_scc0 g_noep2
    v_mov_b32 v10, 0
    v_mov_b32 v11, s15
    s_mov_b32 s66, 196608
    s_mov_b64 exec, 1
    buffer_store_dword v11, v10, s[40:43], s66 offen sc0 sc1
    s_mov_b64 exec, -1
g_noep2:
    s_cmp_eq_u32 s9, 2
    s_cbranch_scc0 g_npf2
    v_lshlrev_b32 v10, 7, v0
    v_add_u32 v10, g_red - k_pcref, v10
    s_mov_b32 s66, k_end - k_pcref - 4
    v_min_i32 v10, s66, v10
    v_mov_b32 v13, s77
    v_ashrrev_i32 v11, 31, v10
    v_add_co_u32 v12, vcc, s76, v10
    s_nop 1
    v_addc_co_u32 v13, vcc, v11, v13, vcc
    global_load_dword v14, v[12:13], off
g_npf2:
    s_cmp_eq_u32 s9, 3
    s_cbranch_scc0 g_npf3
    v_lshlrev_b32 v10, 7, v0
    v_add_u32 v10, a_epi - k_pcref, v10
    s_mov_b32 s66, a_fallback - k_pcref - 4
    v_min_i32 v10, s66, v10
    v_mov_b32 v13, s77
    v_ashrrev_i32 v11, 31, v10
    v_add_co_u32 v12, vcc, s76, v10
    s_nop 1
    v_addc_co_u32 v13, vcc, v11, v13, vcc
    global_load_dword v14, v[12:13], off
g_npf3:
    s_mul_i32 s70, s9, 22528
    s_setprio 0
    s_add_u32 m0, s69, 0
    s_nop 0
    buffer_load_dwordx4 v4, s[48:51], s68 offen lds
    s_add_u32 m0, s69, 1024
    s_add_u32 s68, s68, 8192
    buffer_load_dwordx4 v4, s[48:51], s68 offen lds
    s_add_u32 s68, s68, 8192
    buffer_load_dwordx4 v[80:83], v1, s[52:55], s70 offen sc1
    buffer_load_dwordx4 v[84:87], v1, s[56:59], s70 offen sc1
    s_add_u32 s70, s70, 1024
    s_add_u32 m0, s69, 2048
    s_nop 0
    buffer_load_dwordx4 v4, s[48:51], s68 offen lds
    s_add_u32 m0, s69, 3072
    s_add_u32 s68, s68, 8192
    buffer_load_dwordx4 v4, s[48:51], s68 offen lds
    s_add_u32 s68, s68, 8192
    buffer_load_dwordx4 v[88:91], v1, s[52:55], s70 offen sc1
    buffer_load_dwordx4 v[92:95], v1, s[56:59], s70 offen sc1
    s_add_u32 s70, s70, 1024
    s_add_u32 m0, s69, 4096
    s_nop 0
    buffer_load_dwordx4 v4, s[48:51], s68 offen lds
    s_add_u32 m0, s69, 5120
    s_add_u32 s68, s68, 8192
    buffer_load_dwordx4 v4, s[48:51], s68 offen lds
    s_add_u32 s68, s68, 8192
    buffer_load_dwordx4 v[96:99], v1, s[52:55], s70 offen sc1
    buffer_load_dwordx4 v[100:103], v1, s[56:59], s70 offen sc1
    s_add_u32 s70, s70, 1024
    s_add_u32 m0, s69, 6144
    s_nop 0
    buffer_load_dwordx4 v4, s[48:51], s68 offen lds
    s_add_u32 m0, s69, 7168
    s_add_u32 s68, s68, 8192
    buffer_load_dwordx4 v4, s[48:51], s68 offen lds
    s_add_u32 s68, s68, 8192
    buffer_load_dwordx4 v[104:107], v1, s[52:55], s70 offen sc1
    buffer_load_dwordx4 v[108:111], v1, s[56:59], s70 offen sc1
    s_add_u32 s70, s70, 1024
    s_add_u32 m0, s69, 8192
    s_nop 0
    buffer_load_dwordx4 v4, s[48:51], s68 offen lds
    s_add_u32 m0, s69, 9216
    s_add_u32 s68, s68, 8192
    buffer_load_dwordx4 v4, s[48:51], s68 offen lds
    s_add_u32 s68, s68, 8192
    buffer_load_dwordx4 v[112:115], v1, s[52:55], s70 offen sc1
    buffer_load_dwordx4 v[116:119], v1, s[56:59], s70 offen sc1
    s_add_u32 s70, s70, 1024
    s_add_u32 m0, s69, 10240
    s_nop 0
    buffer_load_dwordx4 v4, s[48:51], s68 offen lds
    s_add_u32 m0, s69, 11264
    s_add_u32 s68, s68, 8192
    buffer_load_dwordx4 v4, s[48:51], s68 offen lds
    s_add_u32 s68, s68, 8192
    buffer_load_dwordx4 v[120:123], v1, s[52:55], s70 offen sc1
    buffer_load_dwordx4 v[124:127], v1, s[56:59], s70 offen sc1
    s_add_u32 s70, s70, 1024
    s_waitcnt vmcnt(20)
    ds_read_b64_tr_b16 v[128:129], v5 offset:0
    ds_read_b64_tr_b16 v[130:131], v5 offset:1024
    ds_read_b64_tr_b16 v[132:133], v6 offset:0
    ds_read_b64_tr_b16 v[134:135], v6 offset:1024
    s_waitcnt vmcnt(16)
    ds_read_b64_tr_b16 v[136:137], v5 offset:2048
    ds_read_b64_tr_b16 v[138:139], v5 offset:3072
    ds_read_b64_tr_b16 v[140:141], v6 offset:2048
    ds_read_b64_tr_b16 v[142:143], v6 offset:3072
    s_waitcnt lgkmcnt(4)
    s_add_u32 m0, s69, 0
    s_nop 0
    buffer_load_dwordx4 v4, s[48:51], s68 offen lds
    v_mfma_f32_32x32x16_bf16 v[16:31], v[128:131], v[80:83], 0
    s_add_u32 m0, s69, 1024
    s_add_u32 s68, s68, 8192
    buffer_load_dwordx4 v4, s[48:51], s68 offen lds
    s_add_u32 s68, s68, 8192
    v_mfma_f32_32x32x16_bf16 v[32:47], v[128:131], v[84:87], 0
    v_mfma_f32_32x32x16_bf16 v[48:63], v[132:135], v[80:83], 0
    v_mfma_f32_32x32x16_bf16 v[64:79], v[132:135], v[84:87], 0
    buffer_load_dwordx4 v[80:83], v1, s[52:55], s70 offen sc1
    buffer_load_dwordx4 v[84:87], v1, s[56:59], s70 offen sc1
    s_add_u32 s70, s70, 1024
    s_waitcnt vmcnt(16)
    ds_read_b64_tr_b16 v[128:129], v5 offset:4096
    ds_read_b64_tr_b16 v[130:131], v5 offset:5120
    ds_read_b64_tr_b16 v[132:133], v6 offset:4096
    ds_read_b64_tr_b16 v[134:135], v6 offset:5120
    s_waitcnt lgkmcnt(4)
    s_add_u32 m0, s69, 2048
    s_nop 0
    buffer_load_dwordx4 v4, s[48:51], s68 offen lds
    v_mfma_f32_32x32x16_bf16 v[16:31], v[136:139], v[88:91], v[16:31]
    s_add_u32 m0, s69, 3072
    s_add_u32 s68, s68, 8192
    buffer_load_dwordx4 v4, s[48:51], s68 offen lds
    s_add_u32 s68, s68, 8192
    v_mfma_f32_32x32x16_bf16 v[32:47], v[136:139], v[92:95], v[32:47]
    v_mfma_f32_32x32x16_bf16 v[48:63], v[140:143], v[88:91], v[48:63]
    v_mfma_f32_32x32x16_bf16 v[64:79], v[140:143], v[92:95], v[64:79]
    buffer_load_dwordx4 v[88:91], v1, s[52:55], s70 offen sc1
    buffer_load_dwordx4 v[92:95], v1, s[56:59], s70 offen sc1
    s_add_u32 s70, s70, 1024
    s_waitcnt vmcnt(16)
    ds_read_b64_tr_b16 v[136:137], v5 offset:6144
    ds_read_b64_tr_b16 v[138:139], v5 offset:7168
    ds_read_b64_tr_b16 v[140:141], v6 offset:6144
    ds_read_b64_tr_b16 v[142:143], v6 offset:7168
    s_waitcnt lgkmcnt(4)
    s_add_u32 m0, s69, 4096
    s_nop 0
    buffer_load_dwordx4 v4, s[48:51], s68 offen lds
    v_mfma_f32_32x32x16_bf16 v[16:31], v[128:131], v[96:99], v[16:31]
    s_add_u32 m0, s69, 5120
    s_add_u32 s68, s68, 8192
    buffer_load_dwordx4 v4, s[48:51], s68 offen lds
    s_add_u32 s68, s68, 8192
    v_mfma_f32_32x32x16_bf16 v[32:47], v[128:131], v[100:103], v[32:47]
    v_mfma_f32_32x32x16_bf16 v[48:63], v[132:135], v[96:99], v[48:63]
    v_mfma_f32_32x32x16_bf16 v[64:79], v[132:135], v[100:103], v[64:79]
    buffer_load_dwordx4 v[96:99], v1, s[52:55], s70 offen sc1
    buffer_load_dwordx4 v[100:103], v1, s[56:59], s70 offen sc1
    s_add_u32 s70, s70, 1024
    s_waitcnt vmcnt(16)
    ds_read_b64_tr_b16 v[128:129], v5 offset:8192
    ds_read_b64_tr_b16 v[130:131], v5 offset:9216
    ds_read_b64_tr_b16 v[132:133], v6 offset:8192
    ds_read_b64_tr_b16 v[134:135], v6 offset:9216
    s_waitcnt lgkmcnt(4)
    s_add_u32 m0, s69, 6144
    s_nop 0
    buffer_load_dwordx4 v4, s[48:51], s68 offen lds
    v_mfma_f32_32x32x16_bf16 v[16:31], v[136:139], v[104:107], v[16:31]
    s_add_u32 m0, s69, 7168
    s_add_u32 s68, s68, 8192
    buffer_load_dwordx4 v4, s[48:51], s68 offen lds
    s_add_u32 s68, s68, 8192
    v_mfma_f32_32x32x16_bf16 v[32:47], v[136:139], v[108:111], v[32:47]
    v_mfma_f32_32x32x16_bf16 v[48:63], v[140:143], v[104:107], v[48:63]
    v_mfma_f32_32x32x16_bf16 v[64:79], v[140:143], v[108:111], v[64:79]
    buffer_load_dwordx4 v[104:107], v1, s[52:55], s70 offen sc1
    buffer_load_dwordx4 v[108:111], v1, s[56:59], s70 offen sc1
    s_add_u32 s70, s70, 1024
    s_waitcnt vmcnt(16)
    ds_read_b64_tr_b16 v[136:137], v5 offset:10240
    ds_read_b64_tr_b16 v[138:139], v5 offset:11264
    ds_read_b64_tr_b16 v[140:141], v6 offset:10240
    ds_read_b64_tr_b16 v[142:143], v6 offset:11264
    s_waitcnt lgkmcnt(4)
    s_add_u32 m0, s69, 8192
    s_nop 0
    buffer_load_dwordx4 v4, s[48:51], s68 offen lds
    v_mfma_f32_32x32x16_bf16 v[16:31], v[128:131], v[112:115], v[16:31]
    s_add_u32 m0, s69, 9216
    s_add_u32 s68, s68, 8192
    buffer_load_dwordx4 v4, s[48:51], s68 offen lds
    s_add_u32 s68, s68, 8192
    v_mfma_f32_32x32x16_bf16 v[32:47], v[128:131], v[116:119], v[32:47]
    v_mfma_f32_32x32x16_bf16 v[48:63], v[132:135], v[112:115], v[48:63]
    v_mfma_f32_32x32x16_bf16 v[64:79], v[132:135], v[116:119], v[64:79]
    buffer_load_dwordx4 v[112:115], v1, s[52:55], s70 offen sc1
    buffer_load_dwordx4 v[116:119], v1, s[56:59], s70 offen sc1
    s_add_u32 s70, s70, 1024
    s_waitcnt vmcnt(16)
    ds_read_b64_tr_b16 v[128:129], v5 offset:0
    ds_read_b64_tr_b16 v[130:131], v5 offset:1024
    ds_read_b64_tr_b16 v[132:133], v6 offset:0
    ds_read_b64_tr_b16 v[134:135], v6 offset:1024
    s_waitcnt lgkmcnt(4)
    s_add_u32 m0, s69, 10240
    s_nop 0
    buffer_load_dwordx4 v4, s[48:51], s68 offen lds
    v_mfma_f32_32x32x16_bf16 v[16:31], v[136:139], v[120:123], v[16:31]
    s_add_u32 m0, s69, 11264
    s_add_u32 s68, s68, 8192
    buffer_load_dwordx4 v4, s[48:51], s68 offen lds
    s_add_u32 s68, s68, 8192
    v_mfma_f32_32x32x16_bf16 v[32:47], v[136:139], v[124:127], v[32:47]
    v_mfma_f32_32x32x16_bf16 v[48:63], v[140:143], v[120:123], v[48:63]
    v_mfma_f32_32x32x16_bf16 v[64:79], v[140:143], v[124:127], v[64:79]
    buffer_load_dwordx4 v[120:123], v1, s[52:55], s70 offen sc1
    buffer_load_dwordx4 v[124:127], v1, s[56:59], s70 offen sc1
    s_add_u32 s70, s70, 1024
    s_waitcnt vmcnt(16)
    ds_read_b64_tr_b16 v[136:137], v5 offset:2048
    ds_read_b64_tr_b16 v[138:139], v5 offset:3072
    ds_read_b64_tr_b16 v[140:141], v6 offset:2048
    ds_read_b64_tr_b16 v[142:143], v6 offset:3072
    s_waitcnt lgkmcnt(4)
    s_add_u32 m0, s69, 0
    s_nop 0
    buffer_load_dwordx4 v4, s[48:51], s68 offen lds
    v_mfma_f32_32x32x16_bf16 v[16:31], v[128:131], v[80:83], v[16:31]
    s_add_u32 m0, s69, 1024
    s_add_u32 s68, s68, 8192
    buffer_load_dwordx4 v4, s[48:51], s68 offen lds
    s_add_u32 s68, s68, 8192
    v_mfma_f32_32x32x16_bf16 v[32:47], v[128:131], v[84:87], v[32:47]
    v_mfma_f32_32x32x16_bf16 v[48:63], v[132:135], v[80:83], v[48:63]
    v_mfma_f32_32x32x16_bf16 v[64:79], v[132:135], v[84:87], v[64:79]
    buffer_load_dwordx4 v[80:83], v1, s[52:55], s70 offen sc1
    buffer_load_dwordx4 v[84:87], v1, s[56:59], s70 offen sc1
    s_add_u32 s70, s70, 1024
    s_waitcnt vmcnt(16)
    ds_read_b64_tr_b16 v[128:129], v5 offset:4096
    ds_read_b64_tr_b16 v[130:131], v5 offset:5120
    ds_read_b64_tr_b16 v[132:133], v6 offset:4096
    ds_read_b64_tr_b16 v[134:135], v6 offset:5120
    s_waitcnt lgkmcnt(4)
    s_add_u32 m0, s69, 2048
    s_nop 0
    buffer_load_dwordx4 v4, s[48:51], s68 offen lds
    v_mfma_f32_32x32x16_bf16 v[16:31], v[136:139], v[88:91], v[16:31]
    s_add_u32 m0, s69, 3072
    s_add_u32 s68, s68, 8192
    buffer_load_dwordx4 v4, s[48:51], s68 offen lds
    s_add_u32 s68, s68, 8192
    v_mfma_f32_32x32x16_bf16 v[32:47], v[136:139], v[92:95], v[32:47]
    v_mfma_f32_32x32x16_bf16 v[48:63], v[140:143], v[88:91], v[48:63]
    v_mfma_f32_32x32x16_bf16 v[64:79], v[140:143], v[92:95], v[64:79]
    buffer_load_dwordx4 v[88:91], v1, s[52:55], s70 offen sc1
    buffer_load_dwordx4 v[92:95], v1, s[56:59], s70 offen sc1
    s_add_u32 s70, s70, 1024
    s_waitcnt vmcnt(16)
    ds_read_b64_tr_b16 v[136:137], v5 offset:6144
    ds_read_b64_tr_b16 v[138:139], v5 offset:7168
    ds_read_b64_tr_b16 v[140:141], v6 offset:6144
    ds_read_b64_tr_b16 v[142:143], v6 offset:7168
    s_waitcnt lgkmcnt(4)
    s_add_u32 m0, s69, 4096
    s_nop 0
    buffer_load_dwordx4 v4, s[48:51], s68 offen lds
    v_mfma_f32_32x32x16_bf16 v[16:31], v[128:131], v[96:99], v[16:31]
    s_add_u32 m0, s69, 5120
    s_add_u32 s68, s68, 8192
    buffer_load_dwordx4 v4, s[48:51], s68 offen lds
    s_add_u32 s68, s68, 8192
    v_mfma_f32_32x32x16_bf16 v[32:47], v[128:131], v[100:103], v[32:47]
    v_mfma_f32_32x32x16_bf16 v[48:63], v[132:135], v[96:99], v[48:63]
    v_mfma_f32_32x32x16_bf16 v[64:79], v[132:135], v[100:103], v[64:79]
    buffer_load_dwordx4 v[96:99], v1, s[52:55], s70 offen sc1
    buffer_load_dwordx4 v[100:103], v1, s[56:59], s70 offen sc1
    s_add_u32 s70, s70, 1024
    s_waitcnt vmcnt(16)
    ds_read_b64_tr_b16 v[128:129], v5 offset:8192
    ds_read_b64_tr_b16 v[130:131], v5 offset:9216
    ds_read_b64_tr_b16 v[132:133], v6 offset:8192
    ds_read_b64_tr_b16 v[134:135], v6 offset:9216
    s_waitcnt lgkmcnt(4)
    s_add_u32 m0, s69, 6144
    s_nop 0
    buffer_load_dwordx4 v4, s[48:51], s68 offen lds
    v_mfma_f32_32x32x16_bf16 v[16:31], v[136:139], v[104:107], v[16:31]
    s_add_u32 m0, s69, 7168
    s_add_u32 s68, s68, 8192
    buffer_load_dwordx4 v4, s[48:51], s68 offen lds
    s_add_u32 s68, s68, 8192
    v_mfma_f32_32x32x16_bf16 v[32:47], v[136:139], v[108:111], v[32:47]
    v_mfma_f32_32x32x16_bf16 v[48:63], v[140:143], v[104:107], v[48:63]
    v_mfma_f32_32x32x16_bf16 v[64:79], v[140:143], v[108:111], v[64:79]
    buffer_load_dwordx4 v[104:107], v1, s[52:55], s70 offen sc1
    buffer_load_dwordx4 v[108:111], v1, s[56:59], s70 offen sc1
    s_add_u32 s70, s70, 1024
    s_waitcnt vmcnt(16)
    ds_read_b64_tr_b16 v[136:137], v5 offset:10240
    ds_read_b64_tr_b16 v[138:139], v5 offset:11264
    ds_read_b64_tr_b16 v[140:141], v6 offset:10240
    ds_read_b64_tr_b16 v[142:143], v6 offset:11264
    s_waitcnt lgkmcnt(4)
    s_add_u32 m0, s69, 8192
    s_nop 0
    buffer_load_dwordx4 v4, s[48:51], s68 offen lds
    v_mfma_f32_32x32x16_bf16 v[16:31], v[128:131], v[112:115], v[16:31]
    s_add_u32 m0, s69, 9216
    s_add_u32 s68, s68, 8192
    buffer_load_dwordx4 v4, s[48:51], s68 offen lds
    s_add_u32 s68, s68, 8192
    v_mfma_f32_32x32x16_bf16 v[32:47], v[128:131], v[116:119], v[32:47]
    v_mfma_f32_32x32x16_bf16 v[48:63], v[132:135], v[112:115], v[48:63]
    v_mfma_f32_32x32x16_bf16 v[64:79], v[132:135], v[116:119], v[64:79]
    buffer_load_dwordx4 v[112:115], v1, s[52:55], s70 offen sc1
    buffer_load_dwordx4 v[116:119], v1, s[56:59], s70 offen sc1
    s_add_u32 s70, s70, 1024
    s_waitcnt vmcnt(16)
    ds_read_b64_tr_b16 v[128:129], v5 offset:0
    ds_read_b64_tr_b16 v[130:131], v5 offset:1024
    ds_read_b64_tr_b16 v[132:133], v6 offset:0
    ds_read_b64_tr_b16 v[134:135], v6 offset:1024
    s_waitcnt lgkmcnt(4)
    s_add_u32 m0, s69, 10240
    s_nop 0
    buffer_load_dwordx4 v4, s[48:51], s68 offen lds
    v_mfma_f32_32x32x16_bf16 v[16:31], v[136:139], v[120:123], v[16:31]
    s_add_u32 m0, s69, 11264
    s_add_u32 s68, s68, 8192
    buffer_load_dwordx4 v4, s[48:51], s68 offen lds
    s_add_u32 s68, s68, 8192
    v_mfma_f32_32x32x16_bf16 v[32:47], v[136:139], v[124:127], v[32:47]
    v_mfma_f32_32x32x16_bf16 v[48:63], v[140:143], v[120:123], v[48:63]
    v_mfma_f32_32x32x16_bf16 v[64:79], v[140:143], v[124:127], v[64:79]
    buffer_load_dwordx4 v[120:123], v1, s[52:55], s70 offen sc1
    buffer_load_dwordx4 v[124:127], v1, s[56:59], s70 offen sc1
    s_add_u32 s70, s70, 1024
    s_waitcnt vmcnt(16)
    ds_read_b64_tr_b16 v[136:137], v5 offset:2048
    ds_read_b64_tr_b16 v[138:139], v5 offset:3072
    ds_read_b64_tr_b16 v[140:141], v6 offset:2048
    ds_read_b64_tr_b16 v[142:143], v6 offset:3072
    s_waitcnt lgkmcnt(4)
    s_add_u32 m0, s69, 0
    s_nop 0
    buffer_load_dwordx4 v4, s[48:51], s68 offen lds
    v_mfma_f32_32x32x16_bf16 v[16:31], v[128:131], v[80:83], v[16:31]
    s_add_u32 m0, s69, 1024
    s_add_u32 s68, s68, 8192
    buffer_load_dwordx4 v4, s[48:51], s68 offen lds
    s_add_u32 s68, s68, 8192
    v_mfma_f32_32x32x16_bf16 v[32:47], v[128:131], v[84:87], v[32:47]
    v_mfma_f32_32x32x16_bf16 v[48:63], v[132:135], v[80:83], v[48:63]
    v_mfma_f32_32x32x16_bf16 v[64:79], v[132:135], v[84:87], v[64:79]
    buffer_load_dwordx4 v[80:83], v1, s[52:55], s70 offen sc1
    buffer_load_dwordx4 v[84:87], v1, s[56:59], s70 offen sc1
    s_add_u32 s70, s70, 1024
    s_waitcnt vmcnt(16)
    ds_read_b64_tr_b16 v[128:129], v5 offset:4096
    ds_read_b64_tr_b16 v[130:131], v5 offset:5120
    ds_read_b64_tr_b16 v[132:133], v6 offset:4096
    ds_read_b64_tr_b16 v[134:135], v6 offset:5120
    s_waitcnt lgkmcnt(4)
    s_add_u32 m0, s69, 2048
    s_nop 0
    buffer_load_dwordx4 v4, s[48:51], s68 offen lds
    v_mfma_f32_32x32x16_bf16 v[16:31], v[136:139], v[88:91], v[16:31]
    s_add_u32 m0, s69, 3072
    s_add_u32 s68, s68, 8192
    buffer_load_dwordx4 v4, s[48:51], s68 offen lds
    s_add_u32 s68, s68, 8192
    v_mfma_f32_32x32x16_bf16 v[32:47], v[136:139], v[92:95], v[32:47]
    v_mfma_f32_32x32x16_bf16 v[48:63], v[140:143], v[88:91], v[48:63]
    v_mfma_f32_32x32x16_bf16 v[64:79], v[140:143], v[92:95], v[64:79]
    buffer_load_dwordx4 v[88:91], v1, s[52:55], s70 offen sc1
    buffer_load_dwordx4 v[92:95], v1, s[56:59], s70 offen sc1
    s_add_u32 s70, s70, 1024
    s_waitcnt vmcnt(16)
    ds_read_b64_tr_b16 v[136:137], v5 offset:6144
    ds_read_b64_tr_b16 v[138:139], v5 offset:7168
    ds_read_b64_tr_b16 v[140:141], v6 offset:6144
    ds_read_b64_tr_b16 v[142:143], v6 offset:7168
    s_waitcnt lgkmcnt(4)
    s_add_u32 m0, s69, 4096
    s_nop 0
    buffer_load_dwordx4 v4, s[48:51], s68 offen lds
    v_mfma_f32_32x32x16_bf16 v[16:31], v[128:131], v[96:99], v[16:31]
    s_add_u32 m0, s69, 5120
    s_add_u32 s68, s68, 8192
    buffer_load_dwordx4 v4, s[48:51], s68 offen lds
    s_add_u32 s68, s68, 8192
    v_mfma_f32_32x32x16_bf16 v[32:47], v[128:131], v[100:103], v[32:47]
    v_mfma_f32_32x32x16_bf16 v[48:63], v[132:135], v[96:99], v[48:63]
    v_mfma_f32_32x32x16_bf16 v[64:79], v[132:135], v[100:103], v[64:79]
    buffer_load_dwordx4 v[96:99], v1, s[52:55], s70 offen sc1
    buffer_load_dwordx4 v[100:103], v1, s[56:59], s70 offen sc1
    s_add_u32 s70, s70, 1024
    s_waitcnt vmcnt(16)
    ds_read_b64_tr_b16 v[128:129], v5 offset:8192
    ds_read_b64_tr_b16 v[130:131], v5 offset:9216
    ds_read_b64_tr_b16 v[132:133], v6 offset:8192
    ds_read_b64_tr_b16 v[134:135], v6 offset:9216
    s_waitcnt lgkmcnt(4)
    s_add_u32 m0, s69, 6144
    s_nop 0
    buffer_load_dwordx4 v4, s[48:51], s68 offen lds
    v_mfma_f32_32x32x16_bf16 v[16:31], v[136:139], v[104:107], v[16:31]
    s_add_u32 m0, s69, 7168
    s_add_u32 s68, s68, 8192
    buffer_load_dwordx4 v4, s[48:51], s68 offen lds
    s_add_u32 s68, s68, 8192
    v_mfma_f32_32x32x16_bf16 v[32:47], v[136:139], v[108:111], v[32:47]
    v_mfma_f32_32x32x16_bf16 v[48:63], v[140:143], v[104:107], v[48:63]
    v_mfma_f32_32x32x16_bf16 v[64:79], v[140:143], v[108:111], v[64:79]
    buffer_load_dwordx4 v[104:107], v1, s[52:55], s70 offen sc1
    buffer_load_dwordx4 v[108:111], v1, s[56:59], s70 offen sc1
    s_add_u32 s70, s70, 1024
    s_waitcnt vmcnt(16)
    ds_read_b64_tr_b16 v[136:137], v5 offset:10240
    ds_read_b64_tr_b16 v[138:139], v5 offset:11264
    ds_read_b64_tr_b16 v[140:141], v6 offset:10240
    ds_read_b64_tr_b16 v[142:143], v6 offset:11264
    s_waitcnt lgkmcnt(4)
    v_mfma_f32_32x32x16_bf16 v[16:31], v[128:131], v[112:115], v[16:31]
    v_mfma_f32_32x32x16_bf16 v[32:47], v[128:131], v[116:119], v[32:47]
    v_mfma_f32_32x32x16_bf16 v[48:63], v[132:135], v[112:115], v[48:63]
    v_mfma_f32_32x32x16_bf16 v[64:79], v[132:135], v[116:119], v[64:79]
    s_waitcnt vmcnt(12)
    ds_read_b64_tr_b16 v[128:129], v5 offset:0
    ds_read_b64_tr_b16 v[130:131], v5 offset:1024
    ds_read_b64_tr_b16 v[132:133], v6 offset:0
    ds_read_b64_tr_b16 v[134:135], v6 offset:1024
    s_waitcnt lgkmcnt(4)
    v_mfma_f32_32x32x16_bf16 v[16:31], v[136:139], v[120:123], v[16:31]
    v_mfma_f32_32x32x16_bf16 v[32:47], v[136:139], v[124:127], v[32:47]
    v_mfma_f32_32x32x16_bf16 v[48:63], v[140:143], v[120:123], v[48:63]
    v_mfma_f32_32x32x16_bf16 v[64:79], v[140:143], v[124:127], v[64:79]
    s_waitcnt vmcnt(8)
    ds_read_b64_tr_b16 v[136:137], v5 offset:2048
    ds_read_b64_tr_b16 v[138:139], v5 offset:3072
    ds_read_b64_tr_b16 v[140:141], v6 offset:2048
    ds_read_b64_tr_b16 v[142:143], v6 offset:3072
    s_waitcnt lgkmcnt(4)
    v_mfma_f32_32x32x16_bf16 v[16:31], v[128:131], v[80:83], v[16:31]
    v_mfma_f32_32x32x16_bf16 v[32:47], v[128:131], v[84:87], v[32:47]
    v_mfma_f32_32x32x16_bf16 v[48:63], v[132:135], v[80:83], v[48:63]
    v_mfma_f32_32x32x16_bf16 v[64:79], v[132:135], v[84:87], v[64:79]
    s_waitcnt vmcnt(4)
    ds_read_b64_tr_b16 v[128:129], v5 offset:4096
    ds_read_b64_tr_b16 v[130:131], v5 offset:5120
    ds_read_b64_tr_b16 v[132:133], v6 offset:4096
    ds_read_b64_tr_b16 v[134:135], v6 offset:5120
    s_waitcnt lgkmcnt(4)
    v_mfma_f32_32x32x16_bf16 v[16:31], v[136:139], v[88:91], v[16:31]
    v_mfma_f32_32x32x16_bf16 v[32:47], v[136:139], v[92:95], v[32:47]
    v_mfma_f32_32x32x16_bf16 v[48:63], v[140:143], v[88:91], v[48:63]
    v_mfma_f32_32x32x16_bf16 v[64:79], v[140:143], v[92:95], v[64:79]
    s_waitcnt vmcnt(0)
    ds_read_b64_tr_b16 v[136:137], v5 offset:6144
    ds_read_b64_tr_b16 v[138:139], v5 offset:7168
    ds_read_b64_tr_b16 v[140:141], v6 offset:6144
    ds_read_b64_tr_b16 v[142:143], v6 offset:7168
    s_waitcnt lgkmcnt(4)
    v_mfma_f32_32x32x16_bf16 v[16:31], v[128:131], v[96:99], v[16:31]
    v_mfma_f32_32x32x16_bf16 v[32:47], v[128:131], v[100:103], v[32:47]
    v_mfma_f32_32x32x16_bf16 v[48:63], v[132:135], v[96:99], v[48:63]
    v_mfma_f32_32x32x16_bf16 v[64:79], v[132:135], v[100:103], v[64:79]
    s_waitcnt lgkmcnt(0)
    v_mfma_f32_32x32x16_bf16 v[16:31], v[136:139], v[104:107], v[16:31]
    v_mfma_f32_32x32x16_bf16 v[32:47], v[136:139], v[108:111], v[32:47]
    v_mfma_f32_32x32x16_bf16 v[48:63], v[140:143], v[104:107], v[48:63]
    v_mfma_f32_32x32x16_bf16 v[64:79], v[140:143], v[108:111], v[64:79]
g_red:
    s_setprio 3
    s_nop 7
    s_nop 3
    s_cmp_eq_u32 s9, 0
    s_cbranch_scc1 g_skipw0
    s_sub_u32 s66, 3, s9
    s_and_b32 s66, s66, 3
    s_lshl_b32 s66, s66, 12
    s_add_u32 s66, s66, s69
    v_add_u32 v10, s66, v1
    ds_write_b128 v10, v[16:19] offset:0
    ds_write_b128 v10, v[20:23] offset:1024
    ds_write_b128 v10, v[24:27] offset:2048
    ds_write_b128 v10, v[28:31] offset:3072
g_skipw0:
    s_cmp_eq_u32 s9, 2
    s_cbranch_scc1 g_skipw2
    s_sub_u32 s66, 5, s9
    s_and_b32 s66, s66, 3
    s_lshl_b32 s66, s66, 12
    s_add_u32 s66, s66, s69
    v_add_u32 v10, s66, v1
    ds_write_b128 v10, v[32:35] offset:0
    ds_write_b128 v10, v[36:39] offset:1024
    ds_write_b128 v10, v[40:43] offset:2048
    ds_write_b128 v10, v[44:47] offset:3072
g_skipw2:
    s_cmp_eq_u32 s9, 1
    s_cbranch_scc1 g_skipw1
    s_sub_u32 s66, 4, s9
    s_and_b32 s66, s66, 3
    s_lshl_b32 s66, s66, 12
    s_add_u32 s66, s66, s69
    v_add_u32 v10, s66, v1
    ds_write_b128 v10, v[48:51] offset:0
    ds_write_b128 v10, v[52:55] offset:1024
    ds_write_b128 v10, v[56:59] offset:2048
    ds_write_b128 v10, v[60:63] offset:3072
g_skipw1:
    s_cmp_eq_u32 s9, 3
    s_cbranch_scc1 g_skipw3
    s_sub_u32 s66, 6, s9
    s_and_b32 s66, s66, 3
    s_lshl_b32 s66, s66, 12
    s_add_u32 s66, s66, s69
    v_add_u32 v10, s66, v1
    ds_write_b128 v10, v[64:67] offset:0
    ds_write_b128 v10, v[68:71] offset:1024
    ds_write_b128 v10, v[72:75] offset:2048
    ds_write_b128 v10, v[76:79] offset:3072
g_skipw3:
    s_cmp_eq_u32 s9, 0
    s_cbranch_scc0 g_nmv0
    v_mov_b32 v152, v16
    v_mov_b32 v153, v17
    v_mov_b32 v154, v18
    v_mov_b32 v155, v19
    v_mov_b32 v156, v20
    v_mov_b32 v157, v21
    v_mov_b32 v158, v22
    v_mov_b32 v159, v23
    v_mov_b32 v160, v24
    v_mov_b32 v161, v25
    v_mov_b32 v162, v26
    v_mov_b32 v163, v27
    v_mov_b32 v164, v28
    v_mov_b32 v165, v29
    v_mov_b32 v166, v30
    v_mov_b32 v167, v31
g_nmv0:
    s_cmp_eq_u32 s9, 1
    s_cbranch_scc0 g_nmv1
    v_mov_b32 v152, v48
    v_mov_b32 v153, v49
    v_mov_b32 v154, v50
    v_mov_b32 v155, v51
    v_mov_b32 v156, v52
    v_mov_b32 v157, v53
    v_mov_b32 v158, v54
    v_mov_b32 v159, v55
    v_mov_b32 v160, v56
    v_mov_b32 v161, v57
    v_mov_b32 v162, v58
    v_mov_b32 v163, v59
    v_mov_b32 v164, v60
    v_mov_b32 v165, v61
    v_mov_b32 v166, v62
    v_mov_b32 v167, v63
g_nmv1:
    s_cmp_eq_u32 s9, 2
    s_cbranch_scc0 g_nmv2
    v_mov_b32 v152, v32
    v_mov_b32 v153, v33
    v_mov_b32 v154, v34
    v_mov_b32 v155, v35
    v_mov_b32 v156, v36
    v_mov_b32 v157, v37
    v_mov_b32 v158, v38
    v_mov_b32 v159, v39
    v_mov_b32 v160, v40
    v_mov_b32 v161, v41
    v_mov_b32 v162, v42
    v_mov_b32 v163, v43
    v_mov_b32 v164, v44
    v_mov_b32 v165, v45
    v_mov_b32 v166, v46
    v_mov_b32 v167, v47
g_nmv2:
    s_cmp_eq_u32 s9, 3
    s_cbranch_scc0 g_nmv3
    v_mov_b32 v152, v64
    v_mov_b32 v153, v65
    v_mov_b32 v154, v66
    v_mov_b32 v155, v67
    v_mov_b32 v156, v68
    v_mov_b32 v157, v69
    v_mov_b32 v158, v70
    v_mov_b32 v159, v71
    v_mov_b32 v160, v72
    v_mov_b32 v161, v73
    v_mov_b32 v162, v74
    v_mov_b32 v163, v75
    v_mov_b32 v164, v76
    v_mov_b32 v165, v77
    v_mov_b32 v166, v78
    v_mov_b32 v167, v79
g_nmv3:
    s_waitcnt lgkmcnt(0)
    s_add_u32 s14, s14, 4
    s_mov_b64 exec, 1
    v_mov_b32 v10, 1
    ds_add_u32 v9, v10 offset:12
    s_mov_b64 exec, -1
gs_r1:
    ds_read_b32 v10, v9 offset:12
    s_waitcnt lgkmcnt(0)
    v_readfirstlane_b32 s66, v10
    s_nop 0
    s_cmp_ge_u32 s66, s14
    s_cbranch_scc1 gs_r1_ok
    s_sleep 1
    s_branch gs_r1
gs_r1_ok:
    s_add_u32 s66, s9, 1
    s_and_b32 s66, s66, 3
    s_mov_b32 s68, 32768
    s_cmp_eq_u32 s66, 1
    s_cselect_b32 s68, 48128, s68
    s_cmp_eq_u32 s66, 2
    s_cselect_b32 s68, 132096, s68
    s_cmp_eq_u32 s66, 3
    s_cselect_b32 s68, 147456, s68
    s_add_u32 s68, s68, 8192
    v_add_u32 v10, s68, v1
    s_add_u32 s66, s9, 2
    s_and_b32 s66, s66, 3
    s_mov_b32 s68, 32768
    s_cmp_eq_u32 s66, 1
    s_cselect_b32 s68, 48128, s68
    s_cmp_eq_u32 s66, 2
    s_cselect_b32 s68, 132096, s68
    s_cmp_eq_u32 s66, 3
    s_cselect_b32 s68, 147456, s68
    s_add_u32 s68, s68, 4096
    v_add_u32 v11, s68, v1
    s_add_u32 s66, s9, 3
    s_and_b32 s66, s66, 3
    s_mov_b32 s68, 32768
    s_cmp_eq_u32 s66, 1
    s_cselect_b32 s68, 48128, s68
    s_cmp_eq_u32 s66, 2
    s_cselect_b32 s68, 132096, s68
    s_cmp_eq_u32 s66, 3
    s_cselect_b32 s68, 147456, s68
    s_add_u32 s68, s68, 0
    v_add_u32 v12, s68, v1
    ds_read_b128 v[16:19], v10 offset:0
    ds_read_b128 v[20:23], v10 offset:1024
    ds_read_b128 v[24:27], v10 offset:2048
    ds_read_b128 v[28:31], v10 offset:3072
    ds_read_b128 v[32:35], v11 offset:0
    ds_read_b128 v[36:39], v11 offset:1024
    ds_read_b128 v[40:43], v11 offset:2048
    ds_read_b128 v[44:47], v11 offset:3072
    ds_read_b128 v[48:51], v12 offset:0
    ds_read_b128 v[52:55], v12 offset:1024
    ds_read_b128 v[56:59], v12 offset:2048
    ds_read_b128 v[60:63], v12 offset:3072
    s_waitcnt lgkmcnt(0)
    v_add_f32 v152, v152, v16
    v_add_f32 v32, v32, v48
    v_add_f32 v153, v153, v17
    v_add_f32 v33, v33, v49
    v_add_f32 v154, v154, v18
    v_add_f32 v34, v34, v50
    v_add_f32 v155, v155, v19
    v_add_f32 v35, v35, v51
    v_add_f32 v156, v156, v20
    v_add_f32 v36, v36, v52
    v_add_f32 v157, v157, v21
    v_add_f32 v37, v37, v53
    v_add_f32 v158, v158, v22
    v_add_f32 v38, v38, v54
    v_add_f32 v159, v159, v23
    v_add_f32 v39, v39, v55
    v_add_f32 v160, v160, v24
    v_add_f32 v40, v40, v56
    v_add_f32 v161, v161, v25
    v_add_f32 v41, v41, v57
    v_add_f32 v162, v162, v26
    v_add_f32 v42, v42, v58
    v_add_f32 v163, v163, v27
    v_add_f32 v43, v43, v59
    v_add_f32 v164, v164, v28
    v_add_f32 v44, v44, v60
    v_add_f32 v165, v165, v29
    v_add_f32 v45, v45, v61
    v_add_f32 v166, v166, v30
    v_add_f32 v46, v46, v62
    v_add_f32 v167, v167, v31
    v_add_f32 v47, v47, v63
    v_add_f32 v152, v152, v32
    v_add_f32 v153, v153, v33
    v_add_f32 v154, v154, v34
    v_add_f32 v155, v155, v35
    v_add_f32 v156, v156, v36
    v_add_f32 v157, v157, v37
    v_add_f32 v158, v158, v38
    v_add_f32 v159, v159, v39
    v_add_f32 v160, v160, v40
    v_add_f32 v161, v161, v41
    v_add_f32 v162, v162, v42
    v_add_f32 v163, v163, v43
    v_add_f32 v164, v164, v44
    v_add_f32 v165, v165, v45
    v_add_f32 v166, v166, v46
    v_add_f32 v167, v167, v47
    s_mov_b32 s66, 0xbfb8aa3b
    s_mov_b32 s67, s66
    s_mov_b32 s72, 1.0
    s_mov_b32 s73, 1.0
    v_pk_mul_f32 v[16:17], v[152:153], s[66:67]
    v_pk_mul_f32 v[18:19], v[154:155], s[66:67]
    v_pk_mul_f32 v[20:21], v[156:157], s[66:67]
    v_pk_mul_f32 v[22:23], v[158:159], s[66:67]
    v_pk_mul_f32 v[24:25], v[160:161], s[66:67]
    v_pk_mul_f32 v[26:27], v[162:163], s[66:67]
    v_pk_mul_f32 v[28:29], v[164:165], s[66:67]
    v_pk_mul_f32 v[30:31], v[166:167], s[66:67]
    v_exp_f32 v16, v16
    v_exp_f32 v17, v17
    v_exp_f32 v18, v18
    v_exp_f32 v19, v19
    v_exp_f32 v20, v20
    v_exp_f32 v21, v21
    v_exp_f32 v22, v22
    v_exp_f32 v23, v23
    v_exp_f32 v24, v24
    v_exp_f32 v25, v25
    v_exp_f32 v26, v26
    v_exp_f32 v27, v27
    v_exp_f32 v28, v28
    v_exp_f32 v29, v29
    v_exp_f32 v30, v30
    v_exp_f32 v31, v31
    s_nop 0
    v_pk_add_f32 v[16:17], v[16:17], s[72:73]
    v_pk_add_f32 v[18:19], v[18:19], s[72:73]
    v_pk_add_f32 v[20:21], v[20:21], s[72:73]
    v_pk_add_f32 v[22:23], v[22:23], s[72:73]
    v_pk_add_f32 v[24:25], v[24:25], s[72:73]
    v_pk_add_f32 v[26:27], v[26:27], s[72:73]
    v_pk_add_f32 v[28:29], v[28:29], s[72:73]
    v_pk_add_f32 v[30:31], v[30:31], s[72:73]
    v_rcp_f32 v16, v16
    v_rcp_f32 v17, v17
    v_rcp_f32 v18, v18
    v_rcp_f32 v19, v19
    v_rcp_f32 v20, v20
    v_rcp_f32 v21, v21
    v_rcp_f32 v22, v22
    v_rcp_f32 v23, v23
    v_rcp_f32 v24, v24
    v_rcp_f32 v25, v25
    v_rcp_f32 v26, v26
    v_rcp_f32 v27, v27
    v_rcp_f32 v28, v28
    v_rcp_f32 v29, v29
    v_rcp_f32 v30, v30
    v_rcp_f32 v31, v31
    s_nop 0
    v_pk_mul_f32 v[152:153], v[152:153], v[16:17]
    v_pk_mul_f32 v[154:155], v[154:155], v[18:19]
    v_pk_mul_f32 v[156:157], v[156:157], v[20:21]
    v_pk_mul_f32 v[158:159], v[158:159], v[22:23]
    v_pk_mul_f32 v[160:161], v[160:161], v[24:25]
    v_pk_mul_f32 v[162:163], v[162:163], v[26:27]
    v_pk_mul_f32 v[164:165], v[164:165], v[28:29]
    v_pk_mul_f32 v[166:167], v[166:167], v[30:31]
    s_setprio 0
    s_mov_b32 s48, s16
    s_mov_b32 s49, s17
    s_mov_b32 s50, 2097152
    s_mov_b32 s51, 0x20000
    s_mov_b32 s52, s34
    s_mov_b32 s53, s35
    s_mov_b32 s54, 2097152
    s_mov_b32 s55, 0x20000
    s_lshr_b32 s10, s9, 1
    s_and_b32 s11, s9, 1
    v_lshlrev_b32 v8, 10, v2
    v_lshl_add_u32 v8, v3, 3, v8
    s_lshl_b32 s74, s7, 6
    s_lshl_b32 s66, s10, 5
    s_add_u32 s74, s74, s66
    s_lshl_b32 s74, s74, 10
    s_lshl_b32 s66, s6, 7
    s_add_u32 s74, s74, s66
    s_lshl_b32 s66, s11, 6
    s_add_u32 s74, s74, s66
    buffer_load_dwordx2 v[144:145], v8, s[48:51], s74 offen offset:0
    buffer_load_dwordx2 v[146:147], v8, s[48:51], s74 offen offset:16
    buffer_load_dwordx2 v[148:149], v8, s[48:51], s74 offen offset:32
    buffer_load_dwordx2 v[150:151], v8, s[48:51], s74 offen offset:48
    s_lshl_b32 s66, s11, 15
    s_add_u32 s66, s66, 65536
    v_add_u32 v5, s66, v7
    v_xor_b32 v6, 64, v5
    s_lshl_b32 s70, s7, 10
    s_lshl_b32 s66, s6, 7
    s_add_u32 s70, s70, s66
    s_add_u32 s70, s70, 327680
    v_lshlrev_b32 v10, 2, v0
    s_cmp_eq_u32 s9, 0
    s_cbranch_scc0 g_noop
pf_o:
    buffer_load_dword v11, v10, s[40:43], s70 offen sc1
    s_waitcnt vmcnt(0)
    v_cmp_ne_u32 vcc, s15, v11
    s_nop 0
    s_and_b32 s66, vcc_lo, 0xff
    s_cmp_eq_u32 s66, 0
    s_cbranch_scc1 pf_o_ok
    s_sleep 4
    s_branch pf_o
pf_o_ok:
g_noop:
    s_waitcnt lgkmcnt(0)
    s_add_u32 s14, s14, 4
    s_mov_b64 exec, 1
    v_mov_b32 v10, 1
    ds_add_u32 v9, v10 offset:12
    s_mov_b64 exec, -1
gs_r2:
    ds_read_b32 v10, v9 offset:12
    s_waitcnt lgkmcnt(0)
    v_readfirstlane_b32 s66, v10
    s_nop 0
    s_cmp_ge_u32 s66, s14
    s_cbranch_scc1 gs_r2_ok
    s_sleep 1
    s_branch gs_r2
gs_r2_ok:
    s_lshl_b32 s66, s7, 1
    s_add_u32 s66, s66, s10
    s_lshl_b32 s66, s66, 5
    s_lshl_b32 s67, s11, 4
    s_add_u32 s66, s66, s67
    s_lshl_b32 s66, s66, 10
    s_add_u32 s66, s66, 7340032
    buffer_load_dwordx4 v[80:83], v1, s[40:43], s66 offen offset:0 sc1
    buffer_load_dwordx4 v[84:87], v1, s[40:43], s66 offen offset:1024 sc1
    buffer_load_dwordx4 v[88:91], v1, s[40:43], s66 offen offset:2048 sc1
    buffer_load_dwordx4 v[92:95], v1, s[40:43], s66 offen offset:3072 sc1
    s_add_u32 s66, s66, 4096
    buffer_load_dwordx4 v[96:99], v1, s[40:43], s66 offen offset:0 sc1
    buffer_load_dwordx4 v[100:103], v1, s[40:43], s66 offen offset:1024 sc1
    buffer_load_dwordx4 v[104:107], v1, s[40:43], s66 offen offset:2048 sc1
    buffer_load_dwordx4 v[108:111], v1, s[40:43], s66 offen offset:3072 sc1
    s_add_u32 s66, s66, 4096
    buffer_load_dwordx4 v[112:115], v1, s[40:43], s66 offen offset:0 sc1
    buffer_load_dwordx4 v[116:119], v1, s[40:43], s66 offen offset:1024 sc1
    buffer_load_dwordx4 v[120:123], v1, s[40:43], s66 offen offset:2048 sc1
    buffer_load_dwordx4 v[124:127], v1, s[40:43], s66 offen offset:3072 sc1
    s_add_u32 s66, s66, 4096
    buffer_load_dwordx4 v[128:131], v1, s[40:43], s66 offen offset:0 sc1
    buffer_load_dwordx4 v[132:135], v1, s[40:43], s66 offen offset:1024 sc1
    buffer_load_dwordx4 v[136:139], v1, s[40:43], s66 offen offset:2048 sc1
    buffer_load_dwordx4 v[140:143], v1, s[40:43], s66 offen offset:3072 sc1
    s_add_u32 s66, s66, 4096
    ds_read_b64_tr_b16 v[48:49], v5 offset:0
    ds_read_b64_tr_b16 v[50:51], v5 offset:1024
    ds_read_b64_tr_b16 v[52:53], v6 offset:0
    ds_read_b64_tr_b16 v[54:55], v6 offset:1024
    ds_read_b64_tr_b16 v[56:57], v5 offset:2048
    ds_read_b64_tr_b16 v[58:59], v5 offset:3072
    ds_read_b64_tr_b16 v[60:61], v6 offset:2048
    ds_read_b64_tr_b16 v[62:63], v6 offset:3072
    s_waitcnt vmcnt(15) lgkmcnt(4)
    v_mfma_f32_32x32x16_bf16 v[16:31], v[48:51], v[80:83], 0
    v_mfma_f32_32x32x16_bf16 v[32:47], v[52:55], v[80:83], 0
    ds_read_b64_tr_b16 v[48:49], v5 offset:4096
    ds_read_b64_tr_b16 v[50:51], v5 offset:5120
    ds_read_b64_tr_b16 v[52:53], v6 offset:4096
    ds_read_b64_tr_b16 v[54:55], v6 offset:5120
    s_waitcnt vmcnt(14) lgkmcnt(4)
    v_mfma_f32_32x32x16_bf16 v[16:31], v[56:59], v[84:87], v[16:31]
    v_mfma_f32_32x32x16_bf16 v[32:47], v[60:63], v[84:87], v[32:47]
    ds_read_b64_tr_b16 v[56:57], v5 offset:6144
    ds_read_b64_tr_b16 v[58:59], v5 offset:7168
    ds_read_b64_tr_b16 v[60:61], v6 offset:6144
    ds_read_b64_tr_b16 v[62:63], v6 offset:7168
    s_waitcnt vmcnt(13) lgkmcnt(4)
    v_mfma_f32_32x32x16_bf16 v[16:31], v[48:51], v[88:91], v[16:31]
    v_mfma_f32_32x32x16_bf16 v[32:47], v[52:55], v[88:91], v[32:47]
    ds_read_b64_tr_b16 v[48:49], v5 offset:8192
    ds_read_b64_tr_b16 v[50:51], v5 offset:9216
    ds_read_b64_tr_b16 v[52:53], v6 offset:8192
    ds_read_b64_tr_b16 v[54:55], v6 offset:9216
    s_waitcnt vmcnt(12) lgkmcnt(4)
    v_mfma_f32_32x32x16_bf16 v[16:31], v[56:59], v[92:95], v[16:31]
    v_mfma_f32_32x32x16_bf16 v[32:47], v[60:63], v[92:95], v[32:47]
    ds_read_b64_tr_b16 v[56:57], v5 offset:10240
    ds_read_b64_tr_b16 v[58:59], v5 offset:11264
    ds_read_b64_tr_b16 v[60:61], v6 offset:10240
    ds_read_b64_tr_b16 v[62:63], v6 offset:11264
    s_waitcnt vmcnt(11) lgkmcnt(4)
    v_mfma_f32_32x32x16_bf16 v[16:31], v[48:51], v[96:99], v[16:31]
    v_mfma_f32_32x32x16_bf16 v[32:47], v[52:55], v[96:99], v[32:47]
    ds_read_b64_tr_b16 v[48:49], v5 offset:12288
    ds_read_b64_tr_b16 v[50:51], v5 offset:13312
    ds_read_b64_tr_b16 v[52:53], v6 offset:12288
    ds_read_b64_tr_b16 v[54:55], v6 offset:13312
    s_waitcnt vmcnt(10) lgkmcnt(4)
    v_mfma_f32_32x32x16_bf16 v[16:31], v[56:59], v[100:103], v[16:31]
    v_mfma_f32_32x32x16_bf16 v[32:47], v[60:63], v[100:103], v[32:47]
    ds_read_b64_tr_b16 v[56:57], v5 offset:14336
    ds_read_b64_tr_b16 v[58:59], v5 offset:15360
    ds_read_b64_tr_b16 v[60:61], v6 offset:14336
    ds_read_b64_tr_b16 v[62:63], v6 offset:15360
    s_waitcnt vmcnt(9) lgkmcnt(4)
    v_mfma_f32_32x32x16_bf16 v[16:31], v[48:51], v[104:107], v[16:31]
    v_mfma_f32_32x32x16_bf16 v[32:47], v[52:55], v[104:107], v[32:47]
    ds_read_b64_tr_b16 v[48:49], v5 offset:16384
    ds_read_b64_tr_b16 v[50:51], v5 offset:17408
    ds_read_b64_tr_b16 v[52:53], v6 offset:16384
    ds_read_b64_tr_b16 v[54:55], v6 offset:17408
    s_waitcnt vmcnt(8) lgkmcnt(4)
    v_mfma_f32_32x32x16_bf16 v[16:31], v[56:59], v[108:111], v[16:31]
    v_mfma_f32_32x32x16_bf16 v[32:47], v[60:63], v[108:111], v[32:47]
    ds_read_b64_tr_b16 v[56:57], v5 offset:18432
    ds_read_b64_tr_b16 v[58:59], v5 offset:19456
    ds_read_b64_tr_b16 v[60:61], v6 offset:18432
    ds_read_b64_tr_b16 v[62:63], v6 offset:19456
    s_waitcnt vmcnt(7) lgkmcnt(4)
    v_mfma_f32_32x32x16_bf16 v[16:31], v[48:51], v[112:115], v[16:31]
    v_mfma_f32_32x32x16_bf16 v[32:47], v[52:55], v[112:115], v[32:47]
    ds_read_b64_tr_b16 v[48:49], v5 offset:20480
    ds_read_b64_tr_b16 v[50:51], v5 offset:21504
    ds_read_b64_tr_b16 v[52:53], v6 offset:20480
    ds_read_b64_tr_b16 v[54:55], v6 offset:21504
    s_waitcnt vmcnt(6) lgkmcnt(4)
    v_mfma_f32_32x32x16_bf16 v[16:31], v[56:59], v[116:119], v[16:31]
    v_mfma_f32_32x32x16_bf16 v[32:47], v[60:63], v[116:119], v[32:47]
    ds_read_b64_tr_b16 v[56:57], v5 offset:22528
    ds_read_b64_tr_b16 v[58:59], v5 offset:23552
    ds_read_b64_tr_b16 v[60:61], v6 offset:22528
    ds_read_b64_tr_b16 v[62:63], v6 offset:23552
    s_waitcnt vmcnt(5) lgkmcnt(4)
    v_mfma_f32_32x32x16_bf16 v[16:31], v[48:51], v[120:123], v[16:31]
    v_mfma_f32_32x32x16_bf16 v[32:47], v[52:55], v[120:123], v[32:47]
    ds_read_b64_tr_b16 v[48:49], v5 offset:24576
    ds_read_b64_tr_b16 v[50:51], v5 offset:25600
    ds_read_b64_tr_b16 v[52:53], v6 offset:24576
    ds_read_b64_tr_b16 v[54:55], v6 offset:25600
    s_waitcnt vmcnt(4) lgkmcnt(4)
    v_mfma_f32_32x32x16_bf16 v[16:31], v[56:59], v[124:127], v[16:31]
    v_mfma_f32_32x32x16_bf16 v[32:47], v[60:63], v[124:127], v[32:47]
    ds_read_b64_tr_b16 v[56:57], v5 offset:26624
    ds_read_b64_tr_b16 v[58:59], v5 offset:27648
    ds_read_b64_tr_b16 v[60:61], v6 offset:26624
    ds_read_b64_tr_b16 v[62:63], v6 offset:27648
    s_waitcnt vmcnt(3) lgkmcnt(4)
    v_mfma_f32_32x32x16_bf16 v[16:31], v[48:51], v[128:131], v[16:31]
    v_mfma_f32_32x32x16_bf16 v[32:47], v[52:55], v[128:131], v[32:47]
    ds_read_b64_tr_b16 v[48:49], v5 offset:28672
    ds_read_b64_tr_b16 v[50:51], v5 offset:29696
    ds_read_b64_tr_b16 v[52:53], v6 offset:28672
    ds_read_b64_tr_b16 v[54:55], v6 offset:29696
    s_waitcnt vmcnt(2) lgkmcnt(4)
    v_mfma_f32_32x32x16_bf16 v[16:31], v[56:59], v[132:135], v[16:31]
    v_mfma_f32_32x32x16_bf16 v[32:47], v[60:63], v[132:135], v[32:47]
    ds_read_b64_tr_b16 v[56:57], v5 offset:30720
    ds_read_b64_tr_b16 v[58:59], v5 offset:31744
    ds_read_b64_tr_b16 v[60:61], v6 offset:30720
    ds_read_b64_tr_b16 v[62:63], v6 offset:31744
    s_waitcnt vmcnt(1) lgkmcnt(4)
    v_mfma_f32_32x32x16_bf16 v[16:31], v[48:51], v[136:139], v[16:31]
    v_mfma_f32_32x32x16_bf16 v[32:47], v[52:55], v[136:139], v[32:47]
    s_waitcnt vmcnt(0) lgkmcnt(0)
    v_mfma_f32_32x32x16_bf16 v[16:31], v[56:59], v[140:143], v[16:31]
    v_mfma_f32_32x32x16_bf16 v[32:47], v[60:63], v[140:143], v[32:47]
    s_mov_b32 s68, 32768
    s_cmp_eq_u32 s9, 1
    s_cselect_b32 s68, 36864, s68
    s_cmp_eq_u32 s9, 2
    s_cselect_b32 s68, 132096, s68
    s_cmp_eq_u32 s9, 3
    s_cselect_b32 s68, 136192, s68
    v_add_u32 v9, s68, v1
    s_xor_b32 s9, s9, 1
    s_mov_b32 s69, 32768
    s_cmp_eq_u32 s9, 1
    s_cselect_b32 s69, 36864, s69
    s_cmp_eq_u32 s9, 2
    s_cselect_b32 s69, 132096, s69
    s_cmp_eq_u32 s9, 3
    s_cselect_b32 s69, 136192, s69
    s_xor_b32 s9, s9, 1
    v_add_u32 v10, s69, v1
    s_cmp_eq_u32 s11, 0
    s_cbranch_scc0 g_ex1
    ds_write_b128 v9, v[32:35] offset:0
    ds_write_b128 v9, v[36:39] offset:1024
    ds_write_b128 v9, v[40:43] offset:2048
    ds_write_b128 v9, v[44:47] offset:3072
    s_branch g_exj
g_ex1:
    ds_write_b128 v9, v[16:19] offset:0
    ds_write_b128 v9, v[20:23] offset:1024
    ds_write_b128 v9, v[24:27] offset:2048
    ds_write_b128 v9, v[28:31] offset:3072
    v_mov_b32 v16, v32
    v_mov_b32 v17, v33
    v_mov_b32 v18, v34
    v_mov_b32 v19, v35
    v_mov_b32 v20, v36
    v_mov_b32 v21, v37
    v_mov_b32 v22, v38
    v_mov_b32 v23, v39
    v_mov_b32 v24, v40
    v_mov_b32 v25, v41
    v_mov_b32 v26, v42
    v_mov_b32 v27, v43
    v_mov_b32 v28, v44
    v_mov_b32 v29, v45
    v_mov_b32 v30, v46
    v_mov_b32 v31, v47
g_exj:
    s_waitcnt lgkmcnt(0)
    s_barrier
    ds_read_b128 v[32:35], v10 offset:0
    ds_read_b128 v[36:39], v10 offset:1024
    ds_read_b128 v[40:43], v10 offset:2048
    ds_read_b128 v[44:47], v10 offset:3072
    v_mov_b32 v11, 0xffff0000
    s_waitcnt lgkmcnt(0)
    v_add_f32 v16, v16, v32
    v_add_f32 v17, v17, v33
    v_add_f32 v18, v18, v34
    v_add_f32 v19, v19, v35
    v_add_f32 v20, v20, v36
    v_add_f32 v21, v21, v37
    v_add_f32 v22, v22, v38
    v_add_f32 v23, v23, v39
    v_add_f32 v24, v24, v40
    v_add_f32 v25, v25, v41
    v_add_f32 v26, v26, v42
    v_add_f32 v27, v27, v43
    v_add_f32 v28, v28, v44
    v_add_f32 v29, v29, v45
    v_add_f32 v30, v30, v46
    v_add_f32 v31, v31, v47
    v_lshlrev_b32 v48, 16, v144
    v_and_b32 v49, v11, v144
    v_fma_f32 v48, v16, v152, v48
    v_fma_f32 v49, v17, v153, v49
    v_cvt_pk_bf16_f32 v144, v48, v49
    v_lshlrev_b32 v48, 16, v145
    v_and_b32 v49, v11, v145
    v_fma_f32 v48, v18, v154, v48
    v_fma_f32 v49, v19, v155, v49
    v_cvt_pk_bf16_f32 v145, v48, v49
    buffer_store_dwordx2 v[144:145], v8, s[52:55], s74 offen offset:0
    v_lshlrev_b32 v48, 16, v146
    v_and_b32 v49, v11, v146
    v_fma_f32 v48, v20, v156, v48
    v_fma_f32 v49, v21, v157, v49
    v_cvt_pk_bf16_f32 v146, v48, v49
    v_lshlrev_b32 v48, 16, v147
    v_and_b32 v49, v11, v147
    v_fma_f32 v48, v22, v158, v48
    v_fma_f32 v49, v23, v159, v49
    v_cvt_pk_bf16_f32 v147, v48, v49
    buffer_store_dwordx2 v[146:147], v8, s[52:55], s74 offen offset:16
    v_lshlrev_b32 v48, 16, v148
    v_and_b32 v49, v11, v148
    v_fma_f32 v48, v24, v160, v48
    v_fma_f32 v49, v25, v161, v49
    v_cvt_pk_bf16_f32 v148, v48, v49
    v_lshlrev_b32 v48, 16, v149
    v_and_b32 v49, v11, v149
    v_fma_f32 v48, v26, v162, v48
    v_fma_f32 v49, v27, v163, v49
    v_cvt_pk_bf16_f32 v149, v48, v49
    buffer_store_dwordx2 v[148:149], v8, s[52:55], s74 offen offset:32
    v_lshlrev_b32 v48, 16, v150
    v_and_b32 v49, v11, v150
    v_fma_f32 v48, v28, v164, v48
    v_fma_f32 v49, v29, v165, v49
    v_cvt_pk_bf16_f32 v150, v48, v49
    v_lshlrev_b32 v48, 16, v151
    v_and_b32 v49, v11, v151
    v_fma_f32 v48, v30, v166, v48
    v_fma_f32 v49, v31, v167, v49
    v_cvt_pk_bf16_f32 v151, v48, v49
    buffer_store_dwordx2 v[150:151], v8, s[52:55], s74 offen offset:48
    s_endpgm
k_exit:
    s_endpgm
k_end:
.section .rodata,"a"
.p2align 6
.amdhsa_kernel recurrent_scan__grouped_kv_mqa__glu_gated_swiglu__prompt_kernel
  .amdhsa_next_free_vgpr 168
  .amdhsa_next_free_sgpr 100
  .amdhsa_accum_offset 168
  .amdhsa_group_segment_fixed_size 0
  .amdhsa_kernarg_size 96
  .amdhsa_user_sgpr_count 2
  .amdhsa_user_sgpr_kernarg_segment_ptr 1
  .amdhsa_system_sgpr_workgroup_id_x 1
  .amdhsa_float_denorm_mode_32 3
.end_amdhsa_kernel
```
